```python
import torch

def _softmax(x, axis=-1):
    return torch.softmax(x, dim=axis)
def _gelu(x):
    return torch.nn.functional.gelu(x, approximate="tanh")
def _silu(x):
    return torch.nn.functional.silu(x)
def _sigmoid(x):
    return torch.sigmoid(x)
def _layernorm(x, axis=-1, eps=1e-5):
    m = x.mean(dim=axis, keepdim=True)
    v = x.var(dim=axis, keepdim=True, unbiased=False)
    return (x - m) / torch.sqrt(v + eps)
def _scatter_add(tgt, idx, src, axis=0):
    return tgt.clone().index_add_(axis, idx, src)
def _segment_sum(src, seg, n):
    out = torch.zeros((n,) + src.shape[1:], dtype=src.dtype)
    return out.index_add_(0, seg, src)
def _pad(x, pw):
    flat = tuple(v for pair in reversed(pw) for v in pair)
    return torch.nn.functional.pad(x, flat)

kernel_name = 'concat_heads__gqa_block_cached__sliding_block_cached__decode'

def setup_inputs():

    _w = (lambda a: (lambda t: t.to(torch.bfloat16) if t.is_floating_point() else t)(torch.as_tensor(a)))
    def _A_setup():
        B, Sq, D = 1, 1, 640
        Hq, Hkv, Sk, Dh = 32, 32, 8192, 128
        assert Hq % Hkv == 0, (Hq, Hkv)
        return {
            "x": _w((lambda *s: torch.randn(*s, dtype=torch.bfloat16) * 0.8)(B, Sq, D)),
            "k_cache": _w((lambda *s: torch.randn(*s, dtype=torch.bfloat16) * 1.6)(B, Hkv, Sk, Dh)),
            "v_cache": _w((lambda *s: torch.randn(*s, dtype=torch.bfloat16) * 0.2)(B, Hkv, Sk, Dh)),
            "wq": _w((lambda *s: torch.randn(*s, dtype=torch.bfloat16) * 1.6)(D, Hq * Dh) * (D ** -0.5)),
            "wo": _w((lambda *s: torch.randn(*s, dtype=torch.bfloat16) * 0.2)(Hq * Dh, D) * ((Hq * Dh) ** -0.5)),
        }
    _A_in = _A_setup()

    def _B_setup():
        B, Sq, D = 1, 1, 640
        Hq, Hkv, Sk, Dh = 32, 32, 8192, 128
        assert Hq % Hkv == 0, (Hq, Hkv)
        return {
            "x": _w((lambda *s: torch.randn(*s, dtype=torch.bfloat16) * 0.8)(B, Sq, D)),
            "k_cache": _w((lambda *s: torch.randn(*s, dtype=torch.bfloat16) * 1.6)(B, Hkv, Sk, Dh)),
            "v_cache": _w((lambda *s: torch.randn(*s, dtype=torch.bfloat16) * 0.2)(B, Hkv, Sk, Dh)),
            "wq": _w((lambda *s: torch.randn(*s, dtype=torch.bfloat16) * 1.6)(D, Hq * Dh) * (D ** -0.5)),
            "wo": _w((lambda *s: torch.randn(*s, dtype=torch.bfloat16) * 0.2)(Hq * Dh, D) * ((Hq * Dh) ** -0.5)),
        }
    _B_in = _B_setup()

    return {
        "A_x": _A_in["x"],
        "A_k_cache": _A_in["k_cache"],
        "A_v_cache": _A_in["v_cache"],
        "A_wq": _A_in["wq"],
        "A_wo": _A_in["wo"],
        "B_x": _B_in["x"],
        "B_k_cache": _B_in["k_cache"],
        "B_v_cache": _B_in["v_cache"],
        "B_wq": _B_in["wq"],
        "B_wo": _B_in["wo"],
    }

def reference(A_x, A_k_cache, A_v_cache, A_wq, A_wo, B_x, B_k_cache, B_v_cache, B_wq, B_wo):
    def _A_ref(x, k_cache, v_cache, wq, wo):
        B, Sq, D = x.shape
        Hq, Dh = 32, 128
        Hkv = k_cache.shape[1]
        rep = Hq // Hkv
        q = (lambda x, *d: x.permute(*d))((x @ wq).reshape(B, Sq, Hq, Dh), 0, 2, 1, 3)
        k = (lambda x, n, axis: torch.repeat_interleave(x, n, dim=axis))(k_cache, rep, axis=1)
        v = (lambda x, n, axis: torch.repeat_interleave(x, n, dim=axis))(v_cache, rep, axis=1)
        scores = torch.einsum("bhqd,bhkd->bhqk", q, k) * (Dh ** -0.5)
        p = _softmax(scores, axis=-1)
        o = torch.einsum("bhqk,bhkd->bhqd", p, v)
        return (lambda x, *d: x.permute(*d))(o, 0, 2, 1, 3).reshape(B, Sq, Hq * Dh) @ wo

    def _B_ref(x, k_cache, v_cache, wq, wo):
        B, Sq, D = x.shape
        Hq, Dh = 32, 128
        Hkv, Sk = k_cache.shape[1], k_cache.shape[2]
        W = min(4096, max(256, Sk // 4))
        rep = Hq // Hkv
        q = (lambda x, *d: x.permute(*d))((x @ wq).reshape(B, Sq, Hq, Dh), 0, 2, 1, 3)
        k = (lambda x, n, axis: torch.repeat_interleave(x, n, dim=axis))(k_cache[:, :, Sk - W:, :], rep, axis=1)
        v = (lambda x, n, axis: torch.repeat_interleave(x, n, dim=axis))(v_cache[:, :, Sk - W:, :], rep, axis=1)
        scores = torch.einsum("bhqd,bhkd->bhqk", q, k) * (Dh ** -0.5)
        p = _softmax(scores, axis=-1)
        o = torch.einsum("bhqk,bhkd->bhqd", p, v)
        return (lambda x, *d: x.permute(*d))(o, 0, 2, 1, 3).reshape(B, Sq, Hq * Dh) @ wo

    a = _A_ref(A_x, A_k_cache, A_v_cache, A_wq, A_wo)
    b = _B_ref(B_x, B_k_cache, B_v_cache, B_wq, B_wo)
    return torch.concatenate([a, b], axis=-1)
```

```asm
; @launch kernel=qp_kernel grid=(512,1,1) block=(256,1,1) lds=8192
; @launch kernel=at_kernel grid=(2560,1,1) block=(256,1,1) lds=8448
; @launch kernel=op_kernel grid=(320,1,1) block=(256,1,1) lds=9216
.amdgcn_target "amdgcn-amd-amdhsa--gfx950"
.text
.globl qp_kernel
.p2align 8
.type qp_kernel,@function
qp_kernel:
s_cmp_ge_u32 s2, 512
s_cbranch_scc1 qp_kernel_end
s_lshr_b32 s3, s2, 8
s_load_dwordx2 s[4:5], s[0:1], 0
s_load_dwordx2 s[6:7], s[0:1], 24
s_load_dwordx2 s[10:11], s[0:1], 40
s_load_dwordx2 s[30:31], s[0:1], 64
s_load_dwordx2 s[8:9], s[0:1], 96
s_waitcnt lgkmcnt(0)
s_cmp_ge_u32 s2, 256
s_cselect_b32 s4, s10, s4
s_cselect_b32 s5, s11, s5
s_cselect_b32 s6, s30, s6
s_cselect_b32 s7, s31, s7
s_mov_b32 s12, s4
s_and_b32 s13, s5, 0xffff
s_mov_b32 s14, 1280
s_mov_b32 s15, 0x20000
s_mov_b32 s16, s6
s_and_b32 s17, s7, 0xffff
s_mov_b32 s18, 5242880
s_mov_b32 s19, 0x20000
s_mov_b32 s20, s8
s_and_b32 s21, s9, 0xffff
s_mov_b32 s22, 289409536
s_mov_b32 s23, 0x20000
s_and_b32 s24, s2, 3
s_mul_i32 s24, s24, 160
s_lshr_b32 s25, s2, 2
s_and_b32 s25, s25, 63
s_lshl_b32 s25, s25, 7
v_lshrrev_b32 v1, 3, v0
v_add_u32 v1, s24, v1
v_and_b32 v2, 7, v0
v_lshlrev_b32 v2, 4, v2
v_add_u32 v2, s25, v2
v_lshl_add_u32 v2, v1, 13, v2
v_lshlrev_b32 v3, 1, v1
buffer_load_ushort v24, v3, s[12:15], 0 offen offset:0
buffer_load_dwordx4 v[44:47], v2, s[16:19], 0 offen nt
v_add_u32 v2, 0x40000, v2
buffer_load_ushort v25, v3, s[12:15], 0 offen offset:64
buffer_load_dwordx4 v[48:51], v2, s[16:19], 0 offen nt
v_add_u32 v2, 0x40000, v2
buffer_load_ushort v26, v3, s[12:15], 0 offen offset:128
buffer_load_dwordx4 v[52:55], v2, s[16:19], 0 offen nt
v_add_u32 v2, 0x40000, v2
buffer_load_ushort v27, v3, s[12:15], 0 offen offset:192
buffer_load_dwordx4 v[56:59], v2, s[16:19], 0 offen nt
v_add_u32 v2, 0x40000, v2
buffer_load_ushort v28, v3, s[12:15], 0 offen offset:256
buffer_load_dwordx4 v[60:63], v2, s[16:19], 0 offen nt
v_add_u32 v2, 0x40000, v2
v_mov_b32 v32, 0
v_mov_b32 v33, 0
v_mov_b32 v34, 0
v_mov_b32 v35, 0
v_mov_b32 v36, 0
v_mov_b32 v37, 0
v_mov_b32 v38, 0
v_mov_b32 v39, 0
s_waitcnt vmcnt(0)
v_lshlrev_b32 v23, 16, v24
v_lshlrev_b32 v2, 16, v44
v_and_b32 v3, 0xffff0000, v44
v_fmac_f32 v32, v2, v23
v_fmac_f32 v33, v3, v23
v_lshlrev_b32 v2, 16, v45
v_and_b32 v3, 0xffff0000, v45
v_fmac_f32 v34, v2, v23
v_fmac_f32 v35, v3, v23
v_lshlrev_b32 v2, 16, v46
v_and_b32 v3, 0xffff0000, v46
v_fmac_f32 v36, v2, v23
v_fmac_f32 v37, v3, v23
v_lshlrev_b32 v2, 16, v47
v_and_b32 v3, 0xffff0000, v47
v_fmac_f32 v38, v2, v23
v_fmac_f32 v39, v3, v23
v_lshlrev_b32 v23, 16, v25
v_lshlrev_b32 v2, 16, v48
v_and_b32 v3, 0xffff0000, v48
v_fmac_f32 v32, v2, v23
v_fmac_f32 v33, v3, v23
v_lshlrev_b32 v2, 16, v49
v_and_b32 v3, 0xffff0000, v49
v_fmac_f32 v34, v2, v23
v_fmac_f32 v35, v3, v23
v_lshlrev_b32 v2, 16, v50
v_and_b32 v3, 0xffff0000, v50
v_fmac_f32 v36, v2, v23
v_fmac_f32 v37, v3, v23
v_lshlrev_b32 v2, 16, v51
v_and_b32 v3, 0xffff0000, v51
v_fmac_f32 v38, v2, v23
v_fmac_f32 v39, v3, v23
v_lshlrev_b32 v23, 16, v26
v_lshlrev_b32 v2, 16, v52
v_and_b32 v3, 0xffff0000, v52
v_fmac_f32 v32, v2, v23
v_fmac_f32 v33, v3, v23
v_lshlrev_b32 v2, 16, v53
v_and_b32 v3, 0xffff0000, v53
v_fmac_f32 v34, v2, v23
v_fmac_f32 v35, v3, v23
v_lshlrev_b32 v2, 16, v54
v_and_b32 v3, 0xffff0000, v54
v_fmac_f32 v36, v2, v23
v_fmac_f32 v37, v3, v23
v_lshlrev_b32 v2, 16, v55
v_and_b32 v3, 0xffff0000, v55
v_fmac_f32 v38, v2, v23
v_fmac_f32 v39, v3, v23
v_lshlrev_b32 v23, 16, v27
v_lshlrev_b32 v2, 16, v56
v_and_b32 v3, 0xffff0000, v56
v_fmac_f32 v32, v2, v23
v_fmac_f32 v33, v3, v23
v_lshlrev_b32 v2, 16, v57
v_and_b32 v3, 0xffff0000, v57
v_fmac_f32 v34, v2, v23
v_fmac_f32 v35, v3, v23
v_lshlrev_b32 v2, 16, v58
v_and_b32 v3, 0xffff0000, v58
v_fmac_f32 v36, v2, v23
v_fmac_f32 v37, v3, v23
v_lshlrev_b32 v2, 16, v59
v_and_b32 v3, 0xffff0000, v59
v_fmac_f32 v38, v2, v23
v_fmac_f32 v39, v3, v23
v_lshlrev_b32 v23, 16, v28
v_lshlrev_b32 v2, 16, v60
v_and_b32 v3, 0xffff0000, v60
v_fmac_f32 v32, v2, v23
v_fmac_f32 v33, v3, v23
v_lshlrev_b32 v2, 16, v61
v_and_b32 v3, 0xffff0000, v61
v_fmac_f32 v34, v2, v23
v_fmac_f32 v35, v3, v23
v_lshlrev_b32 v2, 16, v62
v_and_b32 v3, 0xffff0000, v62
v_fmac_f32 v36, v2, v23
v_fmac_f32 v37, v3, v23
v_lshlrev_b32 v2, 16, v63
v_and_b32 v3, 0xffff0000, v63
v_fmac_f32 v38, v2, v23
v_fmac_f32 v39, v3, v23
v_lshlrev_b32 v10, 5, v0
ds_write_b128 v10, v[32:35]
ds_write_b128 v10, v[36:39] offset:16
s_waitcnt lgkmcnt(0)
s_barrier
v_and_b32 v11, 7, v0
v_lshlrev_b32 v12, 2, v11
v_lshrrev_b32 v11, 3, v0
v_lshl_add_u32 v12, v11, 5, v12
v_mov_b32 v20, 0
ds_read_b32 v40, v12 offset:0
ds_read_b32 v41, v12 offset:256
ds_read_b32 v42, v12 offset:512
ds_read_b32 v43, v12 offset:768
ds_read_b32 v44, v12 offset:1024
ds_read_b32 v45, v12 offset:1280
ds_read_b32 v46, v12 offset:1536
ds_read_b32 v47, v12 offset:1792
s_waitcnt lgkmcnt(0)
v_add_f32 v20, v20, v40
v_add_f32 v20, v20, v41
v_add_f32 v20, v20, v42
v_add_f32 v20, v20, v43
v_add_f32 v20, v20, v44
v_add_f32 v20, v20, v45
v_add_f32 v20, v20, v46
v_add_f32 v20, v20, v47
ds_read_b32 v40, v12 offset:2048
ds_read_b32 v41, v12 offset:2304
ds_read_b32 v42, v12 offset:2560
ds_read_b32 v43, v12 offset:2816
ds_read_b32 v44, v12 offset:3072
ds_read_b32 v45, v12 offset:3328
ds_read_b32 v46, v12 offset:3584
ds_read_b32 v47, v12 offset:3840
s_waitcnt lgkmcnt(0)
v_add_f32 v20, v20, v40
v_add_f32 v20, v20, v41
v_add_f32 v20, v20, v42
v_add_f32 v20, v20, v43
v_add_f32 v20, v20, v44
v_add_f32 v20, v20, v45
v_add_f32 v20, v20, v46
v_add_f32 v20, v20, v47
ds_read_b32 v40, v12 offset:4096
ds_read_b32 v41, v12 offset:4352
ds_read_b32 v42, v12 offset:4608
ds_read_b32 v43, v12 offset:4864
ds_read_b32 v44, v12 offset:5120
ds_read_b32 v45, v12 offset:5376
ds_read_b32 v46, v12 offset:5632
ds_read_b32 v47, v12 offset:5888
s_waitcnt lgkmcnt(0)
v_add_f32 v20, v20, v40
v_add_f32 v20, v20, v41
v_add_f32 v20, v20, v42
v_add_f32 v20, v20, v43
v_add_f32 v20, v20, v44
v_add_f32 v20, v20, v45
v_add_f32 v20, v20, v46
v_add_f32 v20, v20, v47
ds_read_b32 v40, v12 offset:6144
ds_read_b32 v41, v12 offset:6400
ds_read_b32 v42, v12 offset:6656
ds_read_b32 v43, v12 offset:6912
ds_read_b32 v44, v12 offset:7168
ds_read_b32 v45, v12 offset:7424
ds_read_b32 v46, v12 offset:7680
ds_read_b32 v47, v12 offset:7936
s_waitcnt lgkmcnt(0)
v_add_f32 v20, v20, v40
v_add_f32 v20, v20, v41
v_add_f32 v20, v20, v42
v_add_f32 v20, v20, v43
v_add_f32 v20, v20, v44
v_add_f32 v20, v20, v45
v_add_f32 v20, v20, v46
v_add_f32 v20, v20, v47
s_and_b32 s24, s2, 3
s_lshl_b32 s24, s24, 14
s_lshl_b32 s3, s3, 16
s_add_u32 s24, s24, s3
s_lshl_b32 s25, s25, 1
s_add_u32 s24, s24, s25
v_lshlrev_b32 v1, 2, v0
v_cmp_gt_u32 vcc, 64, v0
s_and_saveexec_b64 s[26:27], vcc
s_cbranch_execz qp_kernel_end
buffer_store_dword v20, v1, s[20:23], s24 offen
s_waitcnt vmcnt(0)

qp_kernel_end:
s_endpgm
.globl at_kernel
.p2align 8
.type at_kernel,@function
at_kernel:
s_cmp_ge_u32 s2, 2560
s_cbranch_scc1 at_kernel_end
s_load_dwordx4 s[4:7], s[0:1], 8
s_load_dwordx4 s[8:11], s[0:1], 48
s_load_dwordx2 s[28:29], s[0:1], 96
s_waitcnt lgkmcnt(0)
s_lshr_b32 s24, s2, 6
s_and_b32 s25, s2, 63
s_sub_u32 s26, s2, 2048
s_lshr_b32 s27, s26, 4
s_and_b32 s26, s26, 15
s_add_u32 s26, s26, 48
s_cmp_ge_u32 s2, 2048
s_cselect_b32 s4, s8, s4
s_cselect_b32 s5, s9, s5
s_cselect_b32 s6, s10, s6
s_cselect_b32 s7, s11, s7
s_cselect_b32 s24, s27, s24
s_cselect_b32 s25, s26, s25
s_cselect_b32 s30, 0x10000, 0
s_mov_b32 s12, s4
s_and_b32 s13, s5, 0xffff
s_mov_b32 s14, 67108864
s_mov_b32 s15, 0x20000
s_mov_b32 s16, s6
s_and_b32 s17, s7, 0xffff
s_mov_b32 s18, 67108864
s_mov_b32 s19, 0x20000
s_mov_b32 s20, s28
s_and_b32 s21, s29, 0xffff
s_mov_b32 s22, 289409536
s_mov_b32 s23, 0x20000
s_lshl_b32 s31, s24, 9
s_add_u32 s30, s30, s31
v_and_b32 v1, 15, v0
v_lshlrev_b32 v1, 5, v1
s_add_u32 s31, s30, 0
buffer_load_dwordx4 v[32:35], v1, s[20:23], s31 offen
buffer_load_dwordx4 v[36:39], v1, s[20:23], s31 offen offset:16
s_add_u32 s31, s30, 16384
buffer_load_dwordx4 v[40:43], v1, s[20:23], s31 offen
buffer_load_dwordx4 v[44:47], v1, s[20:23], s31 offen offset:16
s_add_u32 s31, s30, 32768
buffer_load_dwordx4 v[48:51], v1, s[20:23], s31 offen
buffer_load_dwordx4 v[52:55], v1, s[20:23], s31 offen offset:16
s_add_u32 s31, s30, 49152
buffer_load_dwordx4 v[56:59], v1, s[20:23], s31 offen
buffer_load_dwordx4 v[60:63], v1, s[20:23], s31 offen offset:16
s_lshl_b32 s31, s24, 21
s_lshl_b32 s25, s25, 15
s_add_u32 s31, s31, s25
v_and_b32 v2, 63, v0
v_lshlrev_b32 v2, 4, v2
v_lshrrev_b32 v3, 6, v0
v_lshl_add_u32 v2, v3, 13, v2
v_add_u32 v2, s31, v2
s_mov_b32 s32, 0
s_mov_b32 s33, 4096
s_mov_b32 s34, 8192
s_mov_b32 s35, 12288
buffer_load_dwordx4 v[64:67], v2, s[12:15], s32 offen offset:0 nt
buffer_load_dwordx4 v[68:71], v2, s[12:15], s32 offen offset:1024 nt
buffer_load_dwordx4 v[72:75], v2, s[12:15], s32 offen offset:2048 nt
buffer_load_dwordx4 v[76:79], v2, s[12:15], s32 offen offset:3072 nt
buffer_load_dwordx4 v[80:83], v2, s[12:15], s33 offen offset:0 nt
buffer_load_dwordx4 v[84:87], v2, s[12:15], s33 offen offset:1024 nt
buffer_load_dwordx4 v[88:91], v2, s[12:15], s33 offen offset:2048 nt
buffer_load_dwordx4 v[92:95], v2, s[12:15], s33 offen offset:3072 nt
buffer_load_dwordx4 v[96:99], v2, s[16:19], s32 offen offset:0 nt
buffer_load_dwordx4 v[100:103], v2, s[16:19], s32 offen offset:1024 nt
buffer_load_dwordx4 v[104:107], v2, s[16:19], s32 offen offset:2048 nt
buffer_load_dwordx4 v[108:111], v2, s[16:19], s32 offen offset:3072 nt
buffer_load_dwordx4 v[112:115], v2, s[16:19], s33 offen offset:0 nt
buffer_load_dwordx4 v[116:119], v2, s[16:19], s33 offen offset:1024 nt
buffer_load_dwordx4 v[120:123], v2, s[16:19], s33 offen offset:2048 nt
buffer_load_dwordx4 v[124:127], v2, s[16:19], s33 offen offset:3072 nt
s_waitcnt vmcnt(16)
v_add_f32 v32, v32, v40
v_add_f32 v33, v33, v41
v_add_f32 v34, v34, v42
v_add_f32 v35, v35, v43
v_add_f32 v36, v36, v44
v_add_f32 v37, v37, v45
v_add_f32 v38, v38, v46
v_add_f32 v39, v39, v47
v_add_f32 v32, v32, v48
v_add_f32 v33, v33, v49
v_add_f32 v34, v34, v50
v_add_f32 v35, v35, v51
v_add_f32 v36, v36, v52
v_add_f32 v37, v37, v53
v_add_f32 v38, v38, v54
v_add_f32 v39, v39, v55
v_add_f32 v32, v32, v56
v_add_f32 v33, v33, v57
v_add_f32 v34, v34, v58
v_add_f32 v35, v35, v59
v_add_f32 v36, v36, v60
v_add_f32 v37, v37, v61
v_add_f32 v38, v38, v62
v_add_f32 v39, v39, v63
v_cvt_pk_bf16_f32 v4, v32, v33
v_cvt_pk_bf16_f32 v5, v34, v35
v_cvt_pk_bf16_f32 v6, v36, v37
v_cvt_pk_bf16_f32 v7, v38, v39
s_waitcnt vmcnt(8)
v_mov_b32 v16, 0
v_dot2_f32_bf16 v16, v64, v4, v16
v_dot2_f32_bf16 v16, v65, v5, v16
v_dot2_f32_bf16 v16, v66, v6, v16
v_dot2_f32_bf16 v16, v67, v7, v16
v_mov_b32 v17, 0
v_dot2_f32_bf16 v17, v68, v4, v17
v_dot2_f32_bf16 v17, v69, v5, v17
v_dot2_f32_bf16 v17, v70, v6, v17
v_dot2_f32_bf16 v17, v71, v7, v17
v_mov_b32 v18, 0
v_dot2_f32_bf16 v18, v72, v4, v18
v_dot2_f32_bf16 v18, v73, v5, v18
v_dot2_f32_bf16 v18, v74, v6, v18
v_dot2_f32_bf16 v18, v75, v7, v18
v_mov_b32 v19, 0
v_dot2_f32_bf16 v19, v76, v4, v19
v_dot2_f32_bf16 v19, v77, v5, v19
v_dot2_f32_bf16 v19, v78, v6, v19
v_dot2_f32_bf16 v19, v79, v7, v19
v_mov_b32 v20, 0
v_dot2_f32_bf16 v20, v80, v4, v20
v_dot2_f32_bf16 v20, v81, v5, v20
v_dot2_f32_bf16 v20, v82, v6, v20
v_dot2_f32_bf16 v20, v83, v7, v20
v_mov_b32 v21, 0
v_dot2_f32_bf16 v21, v84, v4, v21
v_dot2_f32_bf16 v21, v85, v5, v21
v_dot2_f32_bf16 v21, v86, v6, v21
v_dot2_f32_bf16 v21, v87, v7, v21
v_mov_b32 v22, 0
v_dot2_f32_bf16 v22, v88, v4, v22
v_dot2_f32_bf16 v22, v89, v5, v22
v_dot2_f32_bf16 v22, v90, v6, v22
v_dot2_f32_bf16 v22, v91, v7, v22
v_mov_b32 v23, 0
v_dot2_f32_bf16 v23, v92, v4, v23
v_dot2_f32_bf16 v23, v93, v5, v23
v_dot2_f32_bf16 v23, v94, v6, v23
v_dot2_f32_bf16 v23, v95, v7, v23
s_nop 4
v_add_f32_dpp v40, v16, v16 row_ror:8 row_mask:0xf bank_mask:0xf
v_add_f32_dpp v41, v17, v17 row_ror:8 row_mask:0xf bank_mask:0xf
v_add_f32_dpp v42, v18, v18 row_ror:8 row_mask:0xf bank_mask:0xf
v_add_f32_dpp v43, v19, v19 row_ror:8 row_mask:0xf bank_mask:0xf
v_add_f32_dpp v44, v20, v20 row_ror:8 row_mask:0xf bank_mask:0xf
v_add_f32_dpp v45, v21, v21 row_ror:8 row_mask:0xf bank_mask:0xf
v_add_f32_dpp v46, v22, v22 row_ror:8 row_mask:0xf bank_mask:0xf
v_add_f32_dpp v47, v23, v23 row_ror:8 row_mask:0xf bank_mask:0xf
s_nop 1
v_mov_b32 v16, v40
v_mov_b32 v17, v41
v_mov_b32 v18, v42
v_mov_b32 v19, v43
v_mov_b32 v20, v44
v_mov_b32 v21, v45
v_mov_b32 v22, v46
v_mov_b32 v23, v47
s_nop 1
v_add_f32_dpp v40, v16, v16 row_ror:4 row_mask:0xf bank_mask:0xf
v_add_f32_dpp v41, v17, v17 row_ror:4 row_mask:0xf bank_mask:0xf
v_add_f32_dpp v42, v18, v18 row_ror:4 row_mask:0xf bank_mask:0xf
v_add_f32_dpp v43, v19, v19 row_ror:4 row_mask:0xf bank_mask:0xf
v_add_f32_dpp v44, v20, v20 row_ror:4 row_mask:0xf bank_mask:0xf
v_add_f32_dpp v45, v21, v21 row_ror:4 row_mask:0xf bank_mask:0xf
v_add_f32_dpp v46, v22, v22 row_ror:4 row_mask:0xf bank_mask:0xf
v_add_f32_dpp v47, v23, v23 row_ror:4 row_mask:0xf bank_mask:0xf
s_nop 1
v_mov_b32 v16, v40
v_mov_b32 v17, v41
v_mov_b32 v18, v42
v_mov_b32 v19, v43
v_mov_b32 v20, v44
v_mov_b32 v21, v45
v_mov_b32 v22, v46
v_mov_b32 v23, v47
s_nop 1
v_add_f32_dpp v40, v16, v16 row_ror:2 row_mask:0xf bank_mask:0xf
v_add_f32_dpp v41, v17, v17 row_ror:2 row_mask:0xf bank_mask:0xf
v_add_f32_dpp v42, v18, v18 row_ror:2 row_mask:0xf bank_mask:0xf
v_add_f32_dpp v43, v19, v19 row_ror:2 row_mask:0xf bank_mask:0xf
v_add_f32_dpp v44, v20, v20 row_ror:2 row_mask:0xf bank_mask:0xf
v_add_f32_dpp v45, v21, v21 row_ror:2 row_mask:0xf bank_mask:0xf
v_add_f32_dpp v46, v22, v22 row_ror:2 row_mask:0xf bank_mask:0xf
v_add_f32_dpp v47, v23, v23 row_ror:2 row_mask:0xf bank_mask:0xf
s_nop 1
v_mov_b32 v16, v40
v_mov_b32 v17, v41
v_mov_b32 v18, v42
v_mov_b32 v19, v43
v_mov_b32 v20, v44
v_mov_b32 v21, v45
v_mov_b32 v22, v46
v_mov_b32 v23, v47
s_nop 1
v_add_f32_dpp v40, v16, v16 row_ror:1 row_mask:0xf bank_mask:0xf
v_add_f32_dpp v41, v17, v17 row_ror:1 row_mask:0xf bank_mask:0xf
v_add_f32_dpp v42, v18, v18 row_ror:1 row_mask:0xf bank_mask:0xf
v_add_f32_dpp v43, v19, v19 row_ror:1 row_mask:0xf bank_mask:0xf
v_add_f32_dpp v44, v20, v20 row_ror:1 row_mask:0xf bank_mask:0xf
v_add_f32_dpp v45, v21, v21 row_ror:1 row_mask:0xf bank_mask:0xf
v_add_f32_dpp v46, v22, v22 row_ror:1 row_mask:0xf bank_mask:0xf
v_add_f32_dpp v47, v23, v23 row_ror:1 row_mask:0xf bank_mask:0xf
s_nop 1
v_mov_b32 v16, v40
v_mov_b32 v17, v41
v_mov_b32 v18, v42
v_mov_b32 v19, v43
v_mov_b32 v20, v44
v_mov_b32 v21, v45
v_mov_b32 v22, v46
v_mov_b32 v23, v47
s_nop 1
s_mov_b32 s36, 0x3db504f3
v_cvt_pk_bf16_f32 v40, v16, v16
v_lshlrev_b32 v40, 16, v40
v_mul_f32 v40, s36, v40
v_cvt_pk_bf16_f32 v40, v40, v40
v_lshlrev_b32 v16, 16, v40
v_cvt_pk_bf16_f32 v40, v17, v17
v_lshlrev_b32 v40, 16, v40
v_mul_f32 v40, s36, v40
v_cvt_pk_bf16_f32 v40, v40, v40
v_lshlrev_b32 v17, 16, v40
v_cvt_pk_bf16_f32 v40, v18, v18
v_lshlrev_b32 v40, 16, v40
v_mul_f32 v40, s36, v40
v_cvt_pk_bf16_f32 v40, v40, v40
v_lshlrev_b32 v18, 16, v40
v_cvt_pk_bf16_f32 v40, v19, v19
v_lshlrev_b32 v40, 16, v40
v_mul_f32 v40, s36, v40
v_cvt_pk_bf16_f32 v40, v40, v40
v_lshlrev_b32 v19, 16, v40
v_cvt_pk_bf16_f32 v40, v20, v20
v_lshlrev_b32 v40, 16, v40
v_mul_f32 v40, s36, v40
v_cvt_pk_bf16_f32 v40, v40, v40
v_lshlrev_b32 v20, 16, v40
v_cvt_pk_bf16_f32 v40, v21, v21
v_lshlrev_b32 v40, 16, v40
v_mul_f32 v40, s36, v40
v_cvt_pk_bf16_f32 v40, v40, v40
v_lshlrev_b32 v21, 16, v40
v_cvt_pk_bf16_f32 v40, v22, v22
v_lshlrev_b32 v40, 16, v40
v_mul_f32 v40, s36, v40
v_cvt_pk_bf16_f32 v40, v40, v40
v_lshlrev_b32 v22, 16, v40
v_cvt_pk_bf16_f32 v40, v23, v23
v_lshlrev_b32 v40, 16, v40
v_mul_f32 v40, s36, v40
v_cvt_pk_bf16_f32 v40, v40, v40
v_lshlrev_b32 v23, 16, v40
v_mov_b32 v8, v16
v_max_f32 v8, v8, v17
v_max_f32 v8, v8, v18
v_max_f32 v8, v8, v19
v_max_f32 v8, v8, v20
v_max_f32 v8, v8, v21
v_max_f32 v8, v8, v22
v_max_f32 v8, v8, v23
s_mov_b32 s36, 0x3fb8aa3b
v_mov_b32 v9, 0
v_mov_b32 v32, 0
v_mov_b32 v33, 0
v_mov_b32 v34, 0
v_mov_b32 v35, 0
v_mov_b32 v36, 0
v_mov_b32 v37, 0
v_mov_b32 v38, 0
v_mov_b32 v39, 0
v_sub_f32 v16, v16, v8
v_mul_f32 v16, s36, v16
v_exp_f32 v16, v16
s_nop 0
v_add_f32 v9, v9, v16
v_sub_f32 v17, v17, v8
v_mul_f32 v17, s36, v17
v_exp_f32 v17, v17
s_nop 0
v_add_f32 v9, v9, v17
v_sub_f32 v18, v18, v8
v_mul_f32 v18, s36, v18
v_exp_f32 v18, v18
s_nop 0
v_add_f32 v9, v9, v18
v_sub_f32 v19, v19, v8
v_mul_f32 v19, s36, v19
v_exp_f32 v19, v19
s_nop 0
v_add_f32 v9, v9, v19
v_sub_f32 v20, v20, v8
v_mul_f32 v20, s36, v20
v_exp_f32 v20, v20
s_nop 0
v_add_f32 v9, v9, v20
v_sub_f32 v21, v21, v8
v_mul_f32 v21, s36, v21
v_exp_f32 v21, v21
s_nop 0
v_add_f32 v9, v9, v21
v_sub_f32 v22, v22, v8
v_mul_f32 v22, s36, v22
v_exp_f32 v22, v22
s_nop 0
v_add_f32 v9, v9, v22
v_sub_f32 v23, v23, v8
v_mul_f32 v23, s36, v23
v_exp_f32 v23, v23
s_nop 0
v_add_f32 v9, v9, v23
s_waitcnt vmcnt(0)
v_lshlrev_b32 v2, 16, v96
v_and_b32 v3, 0xffff0000, v96
v_fmac_f32 v32, v2, v16
v_fmac_f32 v33, v3, v16
v_lshlrev_b32 v2, 16, v97
v_and_b32 v3, 0xffff0000, v97
v_fmac_f32 v34, v2, v16
v_fmac_f32 v35, v3, v16
v_lshlrev_b32 v2, 16, v98
v_and_b32 v3, 0xffff0000, v98
v_fmac_f32 v36, v2, v16
v_fmac_f32 v37, v3, v16
v_lshlrev_b32 v2, 16, v99
v_and_b32 v3, 0xffff0000, v99
v_fmac_f32 v38, v2, v16
v_fmac_f32 v39, v3, v16
v_lshlrev_b32 v2, 16, v100
v_and_b32 v3, 0xffff0000, v100
v_fmac_f32 v32, v2, v17
v_fmac_f32 v33, v3, v17
v_lshlrev_b32 v2, 16, v101
v_and_b32 v3, 0xffff0000, v101
v_fmac_f32 v34, v2, v17
v_fmac_f32 v35, v3, v17
v_lshlrev_b32 v2, 16, v102
v_and_b32 v3, 0xffff0000, v102
v_fmac_f32 v36, v2, v17
v_fmac_f32 v37, v3, v17
v_lshlrev_b32 v2, 16, v103
v_and_b32 v3, 0xffff0000, v103
v_fmac_f32 v38, v2, v17
v_fmac_f32 v39, v3, v17
v_lshlrev_b32 v2, 16, v104
v_and_b32 v3, 0xffff0000, v104
v_fmac_f32 v32, v2, v18
v_fmac_f32 v33, v3, v18
v_lshlrev_b32 v2, 16, v105
v_and_b32 v3, 0xffff0000, v105
v_fmac_f32 v34, v2, v18
v_fmac_f32 v35, v3, v18
v_lshlrev_b32 v2, 16, v106
v_and_b32 v3, 0xffff0000, v106
v_fmac_f32 v36, v2, v18
v_fmac_f32 v37, v3, v18
v_lshlrev_b32 v2, 16, v107
v_and_b32 v3, 0xffff0000, v107
v_fmac_f32 v38, v2, v18
v_fmac_f32 v39, v3, v18
v_lshlrev_b32 v2, 16, v108
v_and_b32 v3, 0xffff0000, v108
v_fmac_f32 v32, v2, v19
v_fmac_f32 v33, v3, v19
v_lshlrev_b32 v2, 16, v109
v_and_b32 v3, 0xffff0000, v109
v_fmac_f32 v34, v2, v19
v_fmac_f32 v35, v3, v19
v_lshlrev_b32 v2, 16, v110
v_and_b32 v3, 0xffff0000, v110
v_fmac_f32 v36, v2, v19
v_fmac_f32 v37, v3, v19
v_lshlrev_b32 v2, 16, v111
v_and_b32 v3, 0xffff0000, v111
v_fmac_f32 v38, v2, v19
v_fmac_f32 v39, v3, v19
v_lshlrev_b32 v2, 16, v112
v_and_b32 v3, 0xffff0000, v112
v_fmac_f32 v32, v2, v20
v_fmac_f32 v33, v3, v20
v_lshlrev_b32 v2, 16, v113
v_and_b32 v3, 0xffff0000, v113
v_fmac_f32 v34, v2, v20
v_fmac_f32 v35, v3, v20
v_lshlrev_b32 v2, 16, v114
v_and_b32 v3, 0xffff0000, v114
v_fmac_f32 v36, v2, v20
v_fmac_f32 v37, v3, v20
v_lshlrev_b32 v2, 16, v115
v_and_b32 v3, 0xffff0000, v115
v_fmac_f32 v38, v2, v20
v_fmac_f32 v39, v3, v20
v_lshlrev_b32 v2, 16, v116
v_and_b32 v3, 0xffff0000, v116
v_fmac_f32 v32, v2, v21
v_fmac_f32 v33, v3, v21
v_lshlrev_b32 v2, 16, v117
v_and_b32 v3, 0xffff0000, v117
v_fmac_f32 v34, v2, v21
v_fmac_f32 v35, v3, v21
v_lshlrev_b32 v2, 16, v118
v_and_b32 v3, 0xffff0000, v118
v_fmac_f32 v36, v2, v21
v_fmac_f32 v37, v3, v21
v_lshlrev_b32 v2, 16, v119
v_and_b32 v3, 0xffff0000, v119
v_fmac_f32 v38, v2, v21
v_fmac_f32 v39, v3, v21
v_lshlrev_b32 v2, 16, v120
v_and_b32 v3, 0xffff0000, v120
v_fmac_f32 v32, v2, v22
v_fmac_f32 v33, v3, v22
v_lshlrev_b32 v2, 16, v121
v_and_b32 v3, 0xffff0000, v121
v_fmac_f32 v34, v2, v22
v_fmac_f32 v35, v3, v22
v_lshlrev_b32 v2, 16, v122
v_and_b32 v3, 0xffff0000, v122
v_fmac_f32 v36, v2, v22
v_fmac_f32 v37, v3, v22
v_lshlrev_b32 v2, 16, v123
v_and_b32 v3, 0xffff0000, v123
v_fmac_f32 v38, v2, v22
v_fmac_f32 v39, v3, v22
v_lshlrev_b32 v2, 16, v124
v_and_b32 v3, 0xffff0000, v124
v_fmac_f32 v32, v2, v23
v_fmac_f32 v33, v3, v23
v_lshlrev_b32 v2, 16, v125
v_and_b32 v3, 0xffff0000, v125
v_fmac_f32 v34, v2, v23
v_fmac_f32 v35, v3, v23
v_lshlrev_b32 v2, 16, v126
v_and_b32 v3, 0xffff0000, v126
v_fmac_f32 v36, v2, v23
v_fmac_f32 v37, v3, v23
v_lshlrev_b32 v2, 16, v127
v_and_b32 v3, 0xffff0000, v127
v_fmac_f32 v38, v2, v23
v_fmac_f32 v39, v3, v23
v_lshlrev_b32 v10, 5, v0
ds_write_b128 v10, v[32:35]
ds_write_b128 v10, v[36:39] offset:16
v_lshrrev_b32 v11, 4, v0
v_lshlrev_b32 v11, 3, v11
ds_write_b64 v11, v[8:9] offset:8192
s_waitcnt lgkmcnt(0)
s_barrier
v_cmp_gt_u32 vcc, 128, v0
s_and_saveexec_b64 s[26:27], vcc
s_cbranch_execz at_kernel_end
v_mov_b32 v12, 0
ds_read_b64 v[40:41], v12 offset:8192
ds_read_b64 v[42:43], v12 offset:8200
ds_read_b64 v[44:45], v12 offset:8208
ds_read_b64 v[46:47], v12 offset:8216
ds_read_b64 v[48:49], v12 offset:8224
ds_read_b64 v[50:51], v12 offset:8232
ds_read_b64 v[52:53], v12 offset:8240
ds_read_b64 v[54:55], v12 offset:8248
ds_read_b64 v[56:57], v12 offset:8256
ds_read_b64 v[58:59], v12 offset:8264
ds_read_b64 v[60:61], v12 offset:8272
ds_read_b64 v[62:63], v12 offset:8280
ds_read_b64 v[64:65], v12 offset:8288
ds_read_b64 v[66:67], v12 offset:8296
ds_read_b64 v[68:69], v12 offset:8304
ds_read_b64 v[70:71], v12 offset:8312
v_lshlrev_b32 v12, 2, v0
ds_read_b32 v72, v12 offset:0
ds_read_b32 v73, v12 offset:512
ds_read_b32 v74, v12 offset:1024
ds_read_b32 v75, v12 offset:1536
ds_read_b32 v76, v12 offset:2048
ds_read_b32 v77, v12 offset:2560
ds_read_b32 v78, v12 offset:3072
ds_read_b32 v79, v12 offset:3584
ds_read_b32 v80, v12 offset:4096
ds_read_b32 v81, v12 offset:4608
ds_read_b32 v82, v12 offset:5120
ds_read_b32 v83, v12 offset:5632
ds_read_b32 v84, v12 offset:6144
ds_read_b32 v85, v12 offset:6656
ds_read_b32 v86, v12 offset:7168
ds_read_b32 v87, v12 offset:7680
s_waitcnt lgkmcnt(0)
v_mov_b32 v8, v40
v_max_f32 v8, v8, v42
v_max_f32 v8, v8, v44
v_max_f32 v8, v8, v46
v_max_f32 v8, v8, v48
v_max_f32 v8, v8, v50
v_max_f32 v8, v8, v52
v_max_f32 v8, v8, v54
v_max_f32 v8, v8, v56
v_max_f32 v8, v8, v58
v_max_f32 v8, v8, v60
v_max_f32 v8, v8, v62
v_max_f32 v8, v8, v64
v_max_f32 v8, v8, v66
v_max_f32 v8, v8, v68
v_max_f32 v8, v8, v70
v_mov_b32 v9, 0
v_mov_b32 v20, 0
v_sub_f32 v21, v40, v8
v_mul_f32 v21, s36, v21
v_exp_f32 v21, v21
s_nop 0
v_fmac_f32 v9, v21, v41
v_fmac_f32 v20, v21, v72
v_sub_f32 v21, v42, v8
v_mul_f32 v21, s36, v21
v_exp_f32 v21, v21
s_nop 0
v_fmac_f32 v9, v21, v43
v_fmac_f32 v20, v21, v73
v_sub_f32 v21, v44, v8
v_mul_f32 v21, s36, v21
v_exp_f32 v21, v21
s_nop 0
v_fmac_f32 v9, v21, v45
v_fmac_f32 v20, v21, v74
v_sub_f32 v21, v46, v8
v_mul_f32 v21, s36, v21
v_exp_f32 v21, v21
s_nop 0
v_fmac_f32 v9, v21, v47
v_fmac_f32 v20, v21, v75
v_sub_f32 v21, v48, v8
v_mul_f32 v21, s36, v21
v_exp_f32 v21, v21
s_nop 0
v_fmac_f32 v9, v21, v49
v_fmac_f32 v20, v21, v76
v_sub_f32 v21, v50, v8
v_mul_f32 v21, s36, v21
v_exp_f32 v21, v21
s_nop 0
v_fmac_f32 v9, v21, v51
v_fmac_f32 v20, v21, v77
v_sub_f32 v21, v52, v8
v_mul_f32 v21, s36, v21
v_exp_f32 v21, v21
s_nop 0
v_fmac_f32 v9, v21, v53
v_fmac_f32 v20, v21, v78
v_sub_f32 v21, v54, v8
v_mul_f32 v21, s36, v21
v_exp_f32 v21, v21
s_nop 0
v_fmac_f32 v9, v21, v55
v_fmac_f32 v20, v21, v79
v_sub_f32 v21, v56, v8
v_mul_f32 v21, s36, v21
v_exp_f32 v21, v21
s_nop 0
v_fmac_f32 v9, v21, v57
v_fmac_f32 v20, v21, v80
v_sub_f32 v21, v58, v8
v_mul_f32 v21, s36, v21
v_exp_f32 v21, v21
s_nop 0
v_fmac_f32 v9, v21, v59
v_fmac_f32 v20, v21, v81
v_sub_f32 v21, v60, v8
v_mul_f32 v21, s36, v21
v_exp_f32 v21, v21
s_nop 0
v_fmac_f32 v9, v21, v61
v_fmac_f32 v20, v21, v82
v_sub_f32 v21, v62, v8
v_mul_f32 v21, s36, v21
v_exp_f32 v21, v21
s_nop 0
v_fmac_f32 v9, v21, v63
v_fmac_f32 v20, v21, v83
v_sub_f32 v21, v64, v8
v_mul_f32 v21, s36, v21
v_exp_f32 v21, v21
s_nop 0
v_fmac_f32 v9, v21, v65
v_fmac_f32 v20, v21, v84
v_sub_f32 v21, v66, v8
v_mul_f32 v21, s36, v21
v_exp_f32 v21, v21
s_nop 0
v_fmac_f32 v9, v21, v67
v_fmac_f32 v20, v21, v85
v_sub_f32 v21, v68, v8
v_mul_f32 v21, s36, v21
v_exp_f32 v21, v21
s_nop 0
v_fmac_f32 v9, v21, v69
v_fmac_f32 v20, v21, v86
v_sub_f32 v21, v70, v8
v_mul_f32 v21, s36, v21
v_exp_f32 v21, v21
s_nop 0
v_fmac_f32 v9, v21, v71
v_fmac_f32 v20, v21, v87
s_lshl_b32 s31, s2, 9
s_add_u32 s31, s31, 262144
buffer_store_dword v20, v12, s[20:23], s31 offen
s_lshl_b32 s31, s2, 3
s_add_u32 s31, s31, 2097152
v_mov_b32 v12, 0
v_cmp_eq_u32 vcc, 0, v0
s_and_saveexec_b64 s[26:27], vcc
s_cbranch_execz at_kernel_end
buffer_store_dwordx2 v[8:9], v12, s[20:23], s31 offen
s_waitcnt vmcnt(0)

at_kernel_end:
s_endpgm
.globl op_kernel
.p2align 8
.type op_kernel,@function
op_kernel:
s_cmp_ge_u32 s2, 320
s_cbranch_scc1 op_kernel_end
s_load_dwordx2 s[4:5], s[0:1], 32
s_load_dwordx2 s[6:7], s[0:1], 72
s_load_dwordx2 s[28:29], s[0:1], 96
s_load_dwordx4 s[8:11], s[0:1], 80
s_waitcnt lgkmcnt(0)
s_cmp_ge_u32 s2, 160
s_cselect_b32 s4, s6, s4
s_cselect_b32 s5, s7, s5
s_cselect_b32 s3, 1, 0
s_cselect_b32 s24, 160, 0
s_cselect_b32 s38, 16, 64
s_cselect_b32 s39, 2048, 0
s_sub_u32 s24, s2, s24
s_mul_i32 s25, s24, 6554
s_lshr_b32 s25, s25, 16
s_mul_i32 s26, s25, 10
s_sub_u32 s26, s24, s26
s_mov_b32 s16, s4
s_and_b32 s17, s5, 0xffff
s_mov_b32 s18, 5242880
s_mov_b32 s19, 0x20000
s_mov_b32 s20, s28
s_and_b32 s21, s29, 0xffff
s_mov_b32 s22, 289409536
s_mov_b32 s23, 0x20000
v_lshrrev_b32 v1, 3, v0
s_lshl_b32 s27, s25, 8
v_add_u32 v1, s27, v1
v_mul_u32_u24 v1, 1280, v1
v_and_b32 v2, 7, v0
v_lshlrev_b32 v2, 4, v2
v_add_u32 v2, v1, v2
s_lshl_b32 s27, s26, 7
v_add_u32 v2, s27, v2
buffer_load_dwordx4 v[208:211], v2, s[16:19], 0 offen nt
v_add_u32 v2, 40960, v2
buffer_load_dwordx4 v[212:215], v2, s[16:19], 0 offen nt
v_add_u32 v2, 40960, v2
buffer_load_dwordx4 v[216:219], v2, s[16:19], 0 offen nt
v_add_u32 v2, 40960, v2
buffer_load_dwordx4 v[220:223], v2, s[16:19], 0 offen nt
v_add_u32 v2, 40960, v2
buffer_load_dwordx4 v[224:227], v2, s[16:19], 0 offen nt
v_add_u32 v2, 40960, v2
buffer_load_dwordx4 v[228:231], v2, s[16:19], 0 offen nt
v_add_u32 v2, 40960, v2
buffer_load_dwordx4 v[232:235], v2, s[16:19], 0 offen nt
v_add_u32 v2, 40960, v2
buffer_load_dwordx4 v[236:239], v2, s[16:19], 0 offen nt
v_add_u32 v2, 40960, v2
s_lshl_b32 s27, s25, 1
v_lshrrev_b32 v1, 7, v0
v_add_u32 v1, s27, v1
v_mul_lo_u32 v1, v1, s38
v_add_u32 v1, s39, v1
v_lshlrev_b32 v2, 3, v1
v_add_u32 v2, 2097152, v2
v_and_b32 v3, 127, v0
v_lshlrev_b32 v3, 2, v3
v_lshl_add_u32 v3, v1, 9, v3
v_add_u32 v3, 262144, v3
s_mov_b32 s36, 0x3fb8aa3b
v_mov_b32 v8, 0xff800000
v_mov_b32 v9, 0
v_mov_b32 v20, 0
s_cmp_eq_u32 s38, 16
s_cbranch_scc1 op_b
buffer_load_dwordx2 v[112:113], v2, s[20:23], 0 offen offset:0
buffer_load_dword v40, v3, s[20:23], 0 offen
v_add_u32 v3, 512, v3
buffer_load_dwordx2 v[114:115], v2, s[20:23], 0 offen offset:8
buffer_load_dword v41, v3, s[20:23], 0 offen
v_add_u32 v3, 512, v3
buffer_load_dwordx2 v[116:117], v2, s[20:23], 0 offen offset:16
buffer_load_dword v42, v3, s[20:23], 0 offen
v_add_u32 v3, 512, v3
buffer_load_dwordx2 v[118:119], v2, s[20:23], 0 offen offset:24
buffer_load_dword v43, v3, s[20:23], 0 offen
v_add_u32 v3, 512, v3
buffer_load_dwordx2 v[120:121], v2, s[20:23], 0 offen offset:32
buffer_load_dword v44, v3, s[20:23], 0 offen
v_add_u32 v3, 512, v3
buffer_load_dwordx2 v[122:123], v2, s[20:23], 0 offen offset:40
buffer_load_dword v45, v3, s[20:23], 0 offen
v_add_u32 v3, 512, v3
buffer_load_dwordx2 v[124:125], v2, s[20:23], 0 offen offset:48
buffer_load_dword v46, v3, s[20:23], 0 offen
v_add_u32 v3, 512, v3
buffer_load_dwordx2 v[126:127], v2, s[20:23], 0 offen offset:56
buffer_load_dword v47, v3, s[20:23], 0 offen
v_add_u32 v3, 512, v3
buffer_load_dwordx2 v[128:129], v2, s[20:23], 0 offen offset:64
buffer_load_dword v48, v3, s[20:23], 0 offen
v_add_u32 v3, 512, v3
buffer_load_dwordx2 v[130:131], v2, s[20:23], 0 offen offset:72
buffer_load_dword v49, v3, s[20:23], 0 offen
v_add_u32 v3, 512, v3
buffer_load_dwordx2 v[132:133], v2, s[20:23], 0 offen offset:80
buffer_load_dword v50, v3, s[20:23], 0 offen
v_add_u32 v3, 512, v3
buffer_load_dwordx2 v[134:135], v2, s[20:23], 0 offen offset:88
buffer_load_dword v51, v3, s[20:23], 0 offen
v_add_u32 v3, 512, v3
buffer_load_dwordx2 v[136:137], v2, s[20:23], 0 offen offset:96
buffer_load_dword v52, v3, s[20:23], 0 offen
v_add_u32 v3, 512, v3
buffer_load_dwordx2 v[138:139], v2, s[20:23], 0 offen offset:104
buffer_load_dword v53, v3, s[20:23], 0 offen
v_add_u32 v3, 512, v3
buffer_load_dwordx2 v[140:141], v2, s[20:23], 0 offen offset:112
buffer_load_dword v54, v3, s[20:23], 0 offen
v_add_u32 v3, 512, v3
buffer_load_dwordx2 v[142:143], v2, s[20:23], 0 offen offset:120
buffer_load_dword v55, v3, s[20:23], 0 offen
v_add_u32 v3, 512, v3
buffer_load_dwordx2 v[144:145], v2, s[20:23], 0 offen offset:128
buffer_load_dword v56, v3, s[20:23], 0 offen
v_add_u32 v3, 512, v3
buffer_load_dwordx2 v[146:147], v2, s[20:23], 0 offen offset:136
buffer_load_dword v57, v3, s[20:23], 0 offen
v_add_u32 v3, 512, v3
buffer_load_dwordx2 v[148:149], v2, s[20:23], 0 offen offset:144
buffer_load_dword v58, v3, s[20:23], 0 offen
v_add_u32 v3, 512, v3
buffer_load_dwordx2 v[150:151], v2, s[20:23], 0 offen offset:152
buffer_load_dword v59, v3, s[20:23], 0 offen
v_add_u32 v3, 512, v3
buffer_load_dwordx2 v[152:153], v2, s[20:23], 0 offen offset:160
buffer_load_dword v60, v3, s[20:23], 0 offen
v_add_u32 v3, 512, v3
buffer_load_dwordx2 v[154:155], v2, s[20:23], 0 offen offset:168
buffer_load_dword v61, v3, s[20:23], 0 offen
v_add_u32 v3, 512, v3
buffer_load_dwordx2 v[156:157], v2, s[20:23], 0 offen offset:176
buffer_load_dword v62, v3, s[20:23], 0 offen
v_add_u32 v3, 512, v3
buffer_load_dwordx2 v[158:159], v2, s[20:23], 0 offen offset:184
buffer_load_dword v63, v3, s[20:23], 0 offen
v_add_u32 v3, 512, v3
buffer_load_dwordx2 v[160:161], v2, s[20:23], 0 offen offset:192
buffer_load_dword v64, v3, s[20:23], 0 offen
v_add_u32 v3, 512, v3
buffer_load_dwordx2 v[162:163], v2, s[20:23], 0 offen offset:200
buffer_load_dword v65, v3, s[20:23], 0 offen
v_add_u32 v3, 512, v3
buffer_load_dwordx2 v[164:165], v2, s[20:23], 0 offen offset:208
buffer_load_dword v66, v3, s[20:23], 0 offen
v_add_u32 v3, 512, v3
buffer_load_dwordx2 v[166:167], v2, s[20:23], 0 offen offset:216
buffer_load_dword v67, v3, s[20:23], 0 offen
v_add_u32 v3, 512, v3
buffer_load_dwordx2 v[168:169], v2, s[20:23], 0 offen offset:224
buffer_load_dword v68, v3, s[20:23], 0 offen
v_add_u32 v3, 512, v3
buffer_load_dwordx2 v[170:171], v2, s[20:23], 0 offen offset:232
buffer_load_dword v69, v3, s[20:23], 0 offen
v_add_u32 v3, 512, v3
buffer_load_dwordx2 v[172:173], v2, s[20:23], 0 offen offset:240
buffer_load_dword v70, v3, s[20:23], 0 offen
v_add_u32 v3, 512, v3
buffer_load_dwordx2 v[174:175], v2, s[20:23], 0 offen offset:248
buffer_load_dword v71, v3, s[20:23], 0 offen
v_add_u32 v3, 512, v3
s_waitcnt vmcnt(0)
v_mov_b32 v11, v8
v_max_f32 v8, v8, v112
v_max_f32 v8, v8, v114
v_max_f32 v8, v8, v116
v_max_f32 v8, v8, v118
v_max_f32 v8, v8, v120
v_max_f32 v8, v8, v122
v_max_f32 v8, v8, v124
v_max_f32 v8, v8, v126
v_max_f32 v8, v8, v128
v_max_f32 v8, v8, v130
v_max_f32 v8, v8, v132
v_max_f32 v8, v8, v134
v_max_f32 v8, v8, v136
v_max_f32 v8, v8, v138
v_max_f32 v8, v8, v140
v_max_f32 v8, v8, v142
v_max_f32 v8, v8, v144
v_max_f32 v8, v8, v146
v_max_f32 v8, v8, v148
v_max_f32 v8, v8, v150
v_max_f32 v8, v8, v152
v_max_f32 v8, v8, v154
v_max_f32 v8, v8, v156
v_max_f32 v8, v8, v158
v_max_f32 v8, v8, v160
v_max_f32 v8, v8, v162
v_max_f32 v8, v8, v164
v_max_f32 v8, v8, v166
v_max_f32 v8, v8, v168
v_max_f32 v8, v8, v170
v_max_f32 v8, v8, v172
v_max_f32 v8, v8, v174
v_sub_f32 v10, v112, v8
v_mul_f32 v10, s36, v10
v_exp_f32 v10, v10
s_nop 0
v_fmac_f32 v9, v10, v113
v_fmac_f32 v20, v10, v40
v_sub_f32 v10, v114, v8
v_mul_f32 v10, s36, v10
v_exp_f32 v10, v10
s_nop 0
v_fmac_f32 v9, v10, v115
v_fmac_f32 v20, v10, v41
v_sub_f32 v10, v116, v8
v_mul_f32 v10, s36, v10
v_exp_f32 v10, v10
s_nop 0
v_fmac_f32 v9, v10, v117
v_fmac_f32 v20, v10, v42
v_sub_f32 v10, v118, v8
v_mul_f32 v10, s36, v10
v_exp_f32 v10, v10
s_nop 0
v_fmac_f32 v9, v10, v119
v_fmac_f32 v20, v10, v43
v_sub_f32 v10, v120, v8
v_mul_f32 v10, s36, v10
v_exp_f32 v10, v10
s_nop 0
v_fmac_f32 v9, v10, v121
v_fmac_f32 v20, v10, v44
v_sub_f32 v10, v122, v8
v_mul_f32 v10, s36, v10
v_exp_f32 v10, v10
s_nop 0
v_fmac_f32 v9, v10, v123
v_fmac_f32 v20, v10, v45
v_sub_f32 v10, v124, v8
v_mul_f32 v10, s36, v10
v_exp_f32 v10, v10
s_nop 0
v_fmac_f32 v9, v10, v125
v_fmac_f32 v20, v10, v46
v_sub_f32 v10, v126, v8
v_mul_f32 v10, s36, v10
v_exp_f32 v10, v10
s_nop 0
v_fmac_f32 v9, v10, v127
v_fmac_f32 v20, v10, v47
v_sub_f32 v10, v128, v8
v_mul_f32 v10, s36, v10
v_exp_f32 v10, v10
s_nop 0
v_fmac_f32 v9, v10, v129
v_fmac_f32 v20, v10, v48
v_sub_f32 v10, v130, v8
v_mul_f32 v10, s36, v10
v_exp_f32 v10, v10
s_nop 0
v_fmac_f32 v9, v10, v131
v_fmac_f32 v20, v10, v49
v_sub_f32 v10, v132, v8
v_mul_f32 v10, s36, v10
v_exp_f32 v10, v10
s_nop 0
v_fmac_f32 v9, v10, v133
v_fmac_f32 v20, v10, v50
v_sub_f32 v10, v134, v8
v_mul_f32 v10, s36, v10
v_exp_f32 v10, v10
s_nop 0
v_fmac_f32 v9, v10, v135
v_fmac_f32 v20, v10, v51
v_sub_f32 v10, v136, v8
v_mul_f32 v10, s36, v10
v_exp_f32 v10, v10
s_nop 0
v_fmac_f32 v9, v10, v137
v_fmac_f32 v20, v10, v52
v_sub_f32 v10, v138, v8
v_mul_f32 v10, s36, v10
v_exp_f32 v10, v10
s_nop 0
v_fmac_f32 v9, v10, v139
v_fmac_f32 v20, v10, v53
v_sub_f32 v10, v140, v8
v_mul_f32 v10, s36, v10
v_exp_f32 v10, v10
s_nop 0
v_fmac_f32 v9, v10, v141
v_fmac_f32 v20, v10, v54
v_sub_f32 v10, v142, v8
v_mul_f32 v10, s36, v10
v_exp_f32 v10, v10
s_nop 0
v_fmac_f32 v9, v10, v143
v_fmac_f32 v20, v10, v55
v_sub_f32 v10, v144, v8
v_mul_f32 v10, s36, v10
v_exp_f32 v10, v10
s_nop 0
v_fmac_f32 v9, v10, v145
v_fmac_f32 v20, v10, v56
v_sub_f32 v10, v146, v8
v_mul_f32 v10, s36, v10
v_exp_f32 v10, v10
s_nop 0
v_fmac_f32 v9, v10, v147
v_fmac_f32 v20, v10, v57
v_sub_f32 v10, v148, v8
v_mul_f32 v10, s36, v10
v_exp_f32 v10, v10
s_nop 0
v_fmac_f32 v9, v10, v149
v_fmac_f32 v20, v10, v58
v_sub_f32 v10, v150, v8
v_mul_f32 v10, s36, v10
v_exp_f32 v10, v10
s_nop 0
v_fmac_f32 v9, v10, v151
v_fmac_f32 v20, v10, v59
v_sub_f32 v10, v152, v8
v_mul_f32 v10, s36, v10
v_exp_f32 v10, v10
s_nop 0
v_fmac_f32 v9, v10, v153
v_fmac_f32 v20, v10, v60
v_sub_f32 v10, v154, v8
v_mul_f32 v10, s36, v10
v_exp_f32 v10, v10
s_nop 0
v_fmac_f32 v9, v10, v155
v_fmac_f32 v20, v10, v61
v_sub_f32 v10, v156, v8
v_mul_f32 v10, s36, v10
v_exp_f32 v10, v10
s_nop 0
v_fmac_f32 v9, v10, v157
v_fmac_f32 v20, v10, v62
v_sub_f32 v10, v158, v8
v_mul_f32 v10, s36, v10
v_exp_f32 v10, v10
s_nop 0
v_fmac_f32 v9, v10, v159
v_fmac_f32 v20, v10, v63
v_sub_f32 v10, v160, v8
v_mul_f32 v10, s36, v10
v_exp_f32 v10, v10
s_nop 0
v_fmac_f32 v9, v10, v161
v_fmac_f32 v20, v10, v64
v_sub_f32 v10, v162, v8
v_mul_f32 v10, s36, v10
v_exp_f32 v10, v10
s_nop 0
v_fmac_f32 v9, v10, v163
v_fmac_f32 v20, v10, v65
v_sub_f32 v10, v164, v8
v_mul_f32 v10, s36, v10
v_exp_f32 v10, v10
s_nop 0
v_fmac_f32 v9, v10, v165
v_fmac_f32 v20, v10, v66
v_sub_f32 v10, v166, v8
v_mul_f32 v10, s36, v10
v_exp_f32 v10, v10
s_nop 0
v_fmac_f32 v9, v10, v167
v_fmac_f32 v20, v10, v67
v_sub_f32 v10, v168, v8
v_mul_f32 v10, s36, v10
v_exp_f32 v10, v10
s_nop 0
v_fmac_f32 v9, v10, v169
v_fmac_f32 v20, v10, v68
v_sub_f32 v10, v170, v8
v_mul_f32 v10, s36, v10
v_exp_f32 v10, v10
s_nop 0
v_fmac_f32 v9, v10, v171
v_fmac_f32 v20, v10, v69
v_sub_f32 v10, v172, v8
v_mul_f32 v10, s36, v10
v_exp_f32 v10, v10
s_nop 0
v_fmac_f32 v9, v10, v173
v_fmac_f32 v20, v10, v70
v_sub_f32 v10, v174, v8
v_mul_f32 v10, s36, v10
v_exp_f32 v10, v10
s_nop 0
v_fmac_f32 v9, v10, v175
v_fmac_f32 v20, v10, v71
buffer_load_dwordx2 v[112:113], v2, s[20:23], 0 offen offset:256
buffer_load_dword v40, v3, s[20:23], 0 offen
v_add_u32 v3, 512, v3
buffer_load_dwordx2 v[114:115], v2, s[20:23], 0 offen offset:264
buffer_load_dword v41, v3, s[20:23], 0 offen
v_add_u32 v3, 512, v3
buffer_load_dwordx2 v[116:117], v2, s[20:23], 0 offen offset:272
buffer_load_dword v42, v3, s[20:23], 0 offen
v_add_u32 v3, 512, v3
buffer_load_dwordx2 v[118:119], v2, s[20:23], 0 offen offset:280
buffer_load_dword v43, v3, s[20:23], 0 offen
v_add_u32 v3, 512, v3
buffer_load_dwordx2 v[120:121], v2, s[20:23], 0 offen offset:288
buffer_load_dword v44, v3, s[20:23], 0 offen
v_add_u32 v3, 512, v3
buffer_load_dwordx2 v[122:123], v2, s[20:23], 0 offen offset:296
buffer_load_dword v45, v3, s[20:23], 0 offen
v_add_u32 v3, 512, v3
buffer_load_dwordx2 v[124:125], v2, s[20:23], 0 offen offset:304
buffer_load_dword v46, v3, s[20:23], 0 offen
v_add_u32 v3, 512, v3
buffer_load_dwordx2 v[126:127], v2, s[20:23], 0 offen offset:312
buffer_load_dword v47, v3, s[20:23], 0 offen
v_add_u32 v3, 512, v3
buffer_load_dwordx2 v[128:129], v2, s[20:23], 0 offen offset:320
buffer_load_dword v48, v3, s[20:23], 0 offen
v_add_u32 v3, 512, v3
buffer_load_dwordx2 v[130:131], v2, s[20:23], 0 offen offset:328
buffer_load_dword v49, v3, s[20:23], 0 offen
v_add_u32 v3, 512, v3
buffer_load_dwordx2 v[132:133], v2, s[20:23], 0 offen offset:336
buffer_load_dword v50, v3, s[20:23], 0 offen
v_add_u32 v3, 512, v3
buffer_load_dwordx2 v[134:135], v2, s[20:23], 0 offen offset:344
buffer_load_dword v51, v3, s[20:23], 0 offen
v_add_u32 v3, 512, v3
buffer_load_dwordx2 v[136:137], v2, s[20:23], 0 offen offset:352
buffer_load_dword v52, v3, s[20:23], 0 offen
v_add_u32 v3, 512, v3
buffer_load_dwordx2 v[138:139], v2, s[20:23], 0 offen offset:360
buffer_load_dword v53, v3, s[20:23], 0 offen
v_add_u32 v3, 512, v3
buffer_load_dwordx2 v[140:141], v2, s[20:23], 0 offen offset:368
buffer_load_dword v54, v3, s[20:23], 0 offen
v_add_u32 v3, 512, v3
buffer_load_dwordx2 v[142:143], v2, s[20:23], 0 offen offset:376
buffer_load_dword v55, v3, s[20:23], 0 offen
v_add_u32 v3, 512, v3
buffer_load_dwordx2 v[144:145], v2, s[20:23], 0 offen offset:384
buffer_load_dword v56, v3, s[20:23], 0 offen
v_add_u32 v3, 512, v3
buffer_load_dwordx2 v[146:147], v2, s[20:23], 0 offen offset:392
buffer_load_dword v57, v3, s[20:23], 0 offen
v_add_u32 v3, 512, v3
buffer_load_dwordx2 v[148:149], v2, s[20:23], 0 offen offset:400
buffer_load_dword v58, v3, s[20:23], 0 offen
v_add_u32 v3, 512, v3
buffer_load_dwordx2 v[150:151], v2, s[20:23], 0 offen offset:408
buffer_load_dword v59, v3, s[20:23], 0 offen
v_add_u32 v3, 512, v3
buffer_load_dwordx2 v[152:153], v2, s[20:23], 0 offen offset:416
buffer_load_dword v60, v3, s[20:23], 0 offen
v_add_u32 v3, 512, v3
buffer_load_dwordx2 v[154:155], v2, s[20:23], 0 offen offset:424
buffer_load_dword v61, v3, s[20:23], 0 offen
v_add_u32 v3, 512, v3
buffer_load_dwordx2 v[156:157], v2, s[20:23], 0 offen offset:432
buffer_load_dword v62, v3, s[20:23], 0 offen
v_add_u32 v3, 512, v3
buffer_load_dwordx2 v[158:159], v2, s[20:23], 0 offen offset:440
buffer_load_dword v63, v3, s[20:23], 0 offen
v_add_u32 v3, 512, v3
buffer_load_dwordx2 v[160:161], v2, s[20:23], 0 offen offset:448
buffer_load_dword v64, v3, s[20:23], 0 offen
v_add_u32 v3, 512, v3
buffer_load_dwordx2 v[162:163], v2, s[20:23], 0 offen offset:456
buffer_load_dword v65, v3, s[20:23], 0 offen
v_add_u32 v3, 512, v3
buffer_load_dwordx2 v[164:165], v2, s[20:23], 0 offen offset:464
buffer_load_dword v66, v3, s[20:23], 0 offen
v_add_u32 v3, 512, v3
buffer_load_dwordx2 v[166:167], v2, s[20:23], 0 offen offset:472
buffer_load_dword v67, v3, s[20:23], 0 offen
v_add_u32 v3, 512, v3
buffer_load_dwordx2 v[168:169], v2, s[20:23], 0 offen offset:480
buffer_load_dword v68, v3, s[20:23], 0 offen
v_add_u32 v3, 512, v3
buffer_load_dwordx2 v[170:171], v2, s[20:23], 0 offen offset:488
buffer_load_dword v69, v3, s[20:23], 0 offen
v_add_u32 v3, 512, v3
buffer_load_dwordx2 v[172:173], v2, s[20:23], 0 offen offset:496
buffer_load_dword v70, v3, s[20:23], 0 offen
v_add_u32 v3, 512, v3
buffer_load_dwordx2 v[174:175], v2, s[20:23], 0 offen offset:504
buffer_load_dword v71, v3, s[20:23], 0 offen
v_add_u32 v3, 512, v3
s_waitcnt vmcnt(0)
v_mov_b32 v11, v8
v_max_f32 v8, v8, v112
v_max_f32 v8, v8, v114
v_max_f32 v8, v8, v116
v_max_f32 v8, v8, v118
v_max_f32 v8, v8, v120
v_max_f32 v8, v8, v122
v_max_f32 v8, v8, v124
v_max_f32 v8, v8, v126
v_max_f32 v8, v8, v128
v_max_f32 v8, v8, v130
v_max_f32 v8, v8, v132
v_max_f32 v8, v8, v134
v_max_f32 v8, v8, v136
v_max_f32 v8, v8, v138
v_max_f32 v8, v8, v140
v_max_f32 v8, v8, v142
v_max_f32 v8, v8, v144
v_max_f32 v8, v8, v146
v_max_f32 v8, v8, v148
v_max_f32 v8, v8, v150
v_max_f32 v8, v8, v152
v_max_f32 v8, v8, v154
v_max_f32 v8, v8, v156
v_max_f32 v8, v8, v158
v_max_f32 v8, v8, v160
v_max_f32 v8, v8, v162
v_max_f32 v8, v8, v164
v_max_f32 v8, v8, v166
v_max_f32 v8, v8, v168
v_max_f32 v8, v8, v170
v_max_f32 v8, v8, v172
v_max_f32 v8, v8, v174
v_sub_f32 v10, v11, v8
v_mul_f32 v10, s36, v10
v_exp_f32 v10, v10
s_nop 0
v_mul_f32 v9, v9, v10
v_mul_f32 v20, v20, v10
v_sub_f32 v10, v112, v8
v_mul_f32 v10, s36, v10
v_exp_f32 v10, v10
s_nop 0
v_fmac_f32 v9, v10, v113
v_fmac_f32 v20, v10, v40
v_sub_f32 v10, v114, v8
v_mul_f32 v10, s36, v10
v_exp_f32 v10, v10
s_nop 0
v_fmac_f32 v9, v10, v115
v_fmac_f32 v20, v10, v41
v_sub_f32 v10, v116, v8
v_mul_f32 v10, s36, v10
v_exp_f32 v10, v10
s_nop 0
v_fmac_f32 v9, v10, v117
v_fmac_f32 v20, v10, v42
v_sub_f32 v10, v118, v8
v_mul_f32 v10, s36, v10
v_exp_f32 v10, v10
s_nop 0
v_fmac_f32 v9, v10, v119
v_fmac_f32 v20, v10, v43
v_sub_f32 v10, v120, v8
v_mul_f32 v10, s36, v10
v_exp_f32 v10, v10
s_nop 0
v_fmac_f32 v9, v10, v121
v_fmac_f32 v20, v10, v44
v_sub_f32 v10, v122, v8
v_mul_f32 v10, s36, v10
v_exp_f32 v10, v10
s_nop 0
v_fmac_f32 v9, v10, v123
v_fmac_f32 v20, v10, v45
v_sub_f32 v10, v124, v8
v_mul_f32 v10, s36, v10
v_exp_f32 v10, v10
s_nop 0
v_fmac_f32 v9, v10, v125
v_fmac_f32 v20, v10, v46
v_sub_f32 v10, v126, v8
v_mul_f32 v10, s36, v10
v_exp_f32 v10, v10
s_nop 0
v_fmac_f32 v9, v10, v127
v_fmac_f32 v20, v10, v47
v_sub_f32 v10, v128, v8
v_mul_f32 v10, s36, v10
v_exp_f32 v10, v10
s_nop 0
v_fmac_f32 v9, v10, v129
v_fmac_f32 v20, v10, v48
v_sub_f32 v10, v130, v8
v_mul_f32 v10, s36, v10
v_exp_f32 v10, v10
s_nop 0
v_fmac_f32 v9, v10, v131
v_fmac_f32 v20, v10, v49
v_sub_f32 v10, v132, v8
v_mul_f32 v10, s36, v10
v_exp_f32 v10, v10
s_nop 0
v_fmac_f32 v9, v10, v133
v_fmac_f32 v20, v10, v50
v_sub_f32 v10, v134, v8
v_mul_f32 v10, s36, v10
v_exp_f32 v10, v10
s_nop 0
v_fmac_f32 v9, v10, v135
v_fmac_f32 v20, v10, v51
v_sub_f32 v10, v136, v8
v_mul_f32 v10, s36, v10
v_exp_f32 v10, v10
s_nop 0
v_fmac_f32 v9, v10, v137
v_fmac_f32 v20, v10, v52
v_sub_f32 v10, v138, v8
v_mul_f32 v10, s36, v10
v_exp_f32 v10, v10
s_nop 0
v_fmac_f32 v9, v10, v139
v_fmac_f32 v20, v10, v53
v_sub_f32 v10, v140, v8
v_mul_f32 v10, s36, v10
v_exp_f32 v10, v10
s_nop 0
v_fmac_f32 v9, v10, v141
v_fmac_f32 v20, v10, v54
v_sub_f32 v10, v142, v8
v_mul_f32 v10, s36, v10
v_exp_f32 v10, v10
s_nop 0
v_fmac_f32 v9, v10, v143
v_fmac_f32 v20, v10, v55
v_sub_f32 v10, v144, v8
v_mul_f32 v10, s36, v10
v_exp_f32 v10, v10
s_nop 0
v_fmac_f32 v9, v10, v145
v_fmac_f32 v20, v10, v56
v_sub_f32 v10, v146, v8
v_mul_f32 v10, s36, v10
v_exp_f32 v10, v10
s_nop 0
v_fmac_f32 v9, v10, v147
v_fmac_f32 v20, v10, v57
v_sub_f32 v10, v148, v8
v_mul_f32 v10, s36, v10
v_exp_f32 v10, v10
s_nop 0
v_fmac_f32 v9, v10, v149
v_fmac_f32 v20, v10, v58
v_sub_f32 v10, v150, v8
v_mul_f32 v10, s36, v10
v_exp_f32 v10, v10
s_nop 0
v_fmac_f32 v9, v10, v151
v_fmac_f32 v20, v10, v59
v_sub_f32 v10, v152, v8
v_mul_f32 v10, s36, v10
v_exp_f32 v10, v10
s_nop 0
v_fmac_f32 v9, v10, v153
v_fmac_f32 v20, v10, v60
v_sub_f32 v10, v154, v8
v_mul_f32 v10, s36, v10
v_exp_f32 v10, v10
s_nop 0
v_fmac_f32 v9, v10, v155
v_fmac_f32 v20, v10, v61
v_sub_f32 v10, v156, v8
v_mul_f32 v10, s36, v10
v_exp_f32 v10, v10
s_nop 0
v_fmac_f32 v9, v10, v157
v_fmac_f32 v20, v10, v62
v_sub_f32 v10, v158, v8
v_mul_f32 v10, s36, v10
v_exp_f32 v10, v10
s_nop 0
v_fmac_f32 v9, v10, v159
v_fmac_f32 v20, v10, v63
v_sub_f32 v10, v160, v8
v_mul_f32 v10, s36, v10
v_exp_f32 v10, v10
s_nop 0
v_fmac_f32 v9, v10, v161
v_fmac_f32 v20, v10, v64
v_sub_f32 v10, v162, v8
v_mul_f32 v10, s36, v10
v_exp_f32 v10, v10
s_nop 0
v_fmac_f32 v9, v10, v163
v_fmac_f32 v20, v10, v65
v_sub_f32 v10, v164, v8
v_mul_f32 v10, s36, v10
v_exp_f32 v10, v10
s_nop 0
v_fmac_f32 v9, v10, v165
v_fmac_f32 v20, v10, v66
v_sub_f32 v10, v166, v8
v_mul_f32 v10, s36, v10
v_exp_f32 v10, v10
s_nop 0
v_fmac_f32 v9, v10, v167
v_fmac_f32 v20, v10, v67
v_sub_f32 v10, v168, v8
v_mul_f32 v10, s36, v10
v_exp_f32 v10, v10
s_nop 0
v_fmac_f32 v9, v10, v169
v_fmac_f32 v20, v10, v68
v_sub_f32 v10, v170, v8
v_mul_f32 v10, s36, v10
v_exp_f32 v10, v10
s_nop 0
v_fmac_f32 v9, v10, v171
v_fmac_f32 v20, v10, v69
v_sub_f32 v10, v172, v8
v_mul_f32 v10, s36, v10
v_exp_f32 v10, v10
s_nop 0
v_fmac_f32 v9, v10, v173
v_fmac_f32 v20, v10, v70
v_sub_f32 v10, v174, v8
v_mul_f32 v10, s36, v10
v_exp_f32 v10, v10
s_nop 0
v_fmac_f32 v9, v10, v175
v_fmac_f32 v20, v10, v71
s_branch op_j
op_b:
buffer_load_dwordx2 v[112:113], v2, s[20:23], 0 offen offset:0
buffer_load_dword v40, v3, s[20:23], 0 offen
v_add_u32 v3, 512, v3
buffer_load_dwordx2 v[114:115], v2, s[20:23], 0 offen offset:8
buffer_load_dword v41, v3, s[20:23], 0 offen
v_add_u32 v3, 512, v3
buffer_load_dwordx2 v[116:117], v2, s[20:23], 0 offen offset:16
buffer_load_dword v42, v3, s[20:23], 0 offen
v_add_u32 v3, 512, v3
buffer_load_dwordx2 v[118:119], v2, s[20:23], 0 offen offset:24
buffer_load_dword v43, v3, s[20:23], 0 offen
v_add_u32 v3, 512, v3
buffer_load_dwordx2 v[120:121], v2, s[20:23], 0 offen offset:32
buffer_load_dword v44, v3, s[20:23], 0 offen
v_add_u32 v3, 512, v3
buffer_load_dwordx2 v[122:123], v2, s[20:23], 0 offen offset:40
buffer_load_dword v45, v3, s[20:23], 0 offen
v_add_u32 v3, 512, v3
buffer_load_dwordx2 v[124:125], v2, s[20:23], 0 offen offset:48
buffer_load_dword v46, v3, s[20:23], 0 offen
v_add_u32 v3, 512, v3
buffer_load_dwordx2 v[126:127], v2, s[20:23], 0 offen offset:56
buffer_load_dword v47, v3, s[20:23], 0 offen
v_add_u32 v3, 512, v3
buffer_load_dwordx2 v[128:129], v2, s[20:23], 0 offen offset:64
buffer_load_dword v48, v3, s[20:23], 0 offen
v_add_u32 v3, 512, v3
buffer_load_dwordx2 v[130:131], v2, s[20:23], 0 offen offset:72
buffer_load_dword v49, v3, s[20:23], 0 offen
v_add_u32 v3, 512, v3
buffer_load_dwordx2 v[132:133], v2, s[20:23], 0 offen offset:80
buffer_load_dword v50, v3, s[20:23], 0 offen
v_add_u32 v3, 512, v3
buffer_load_dwordx2 v[134:135], v2, s[20:23], 0 offen offset:88
buffer_load_dword v51, v3, s[20:23], 0 offen
v_add_u32 v3, 512, v3
buffer_load_dwordx2 v[136:137], v2, s[20:23], 0 offen offset:96
buffer_load_dword v52, v3, s[20:23], 0 offen
v_add_u32 v3, 512, v3
buffer_load_dwordx2 v[138:139], v2, s[20:23], 0 offen offset:104
buffer_load_dword v53, v3, s[20:23], 0 offen
v_add_u32 v3, 512, v3
buffer_load_dwordx2 v[140:141], v2, s[20:23], 0 offen offset:112
buffer_load_dword v54, v3, s[20:23], 0 offen
v_add_u32 v3, 512, v3
buffer_load_dwordx2 v[142:143], v2, s[20:23], 0 offen offset:120
buffer_load_dword v55, v3, s[20:23], 0 offen
v_add_u32 v3, 512, v3
s_waitcnt vmcnt(0)
v_mov_b32 v11, v8
v_max_f32 v8, v8, v112
v_max_f32 v8, v8, v114
v_max_f32 v8, v8, v116
v_max_f32 v8, v8, v118
v_max_f32 v8, v8, v120
v_max_f32 v8, v8, v122
v_max_f32 v8, v8, v124
v_max_f32 v8, v8, v126
v_max_f32 v8, v8, v128
v_max_f32 v8, v8, v130
v_max_f32 v8, v8, v132
v_max_f32 v8, v8, v134
v_max_f32 v8, v8, v136
v_max_f32 v8, v8, v138
v_max_f32 v8, v8, v140
v_max_f32 v8, v8, v142
v_sub_f32 v10, v112, v8
v_mul_f32 v10, s36, v10
v_exp_f32 v10, v10
s_nop 0
v_fmac_f32 v9, v10, v113
v_fmac_f32 v20, v10, v40
v_sub_f32 v10, v114, v8
v_mul_f32 v10, s36, v10
v_exp_f32 v10, v10
s_nop 0
v_fmac_f32 v9, v10, v115
v_fmac_f32 v20, v10, v41
v_sub_f32 v10, v116, v8
v_mul_f32 v10, s36, v10
v_exp_f32 v10, v10
s_nop 0
v_fmac_f32 v9, v10, v117
v_fmac_f32 v20, v10, v42
v_sub_f32 v10, v118, v8
v_mul_f32 v10, s36, v10
v_exp_f32 v10, v10
s_nop 0
v_fmac_f32 v9, v10, v119
v_fmac_f32 v20, v10, v43
v_sub_f32 v10, v120, v8
v_mul_f32 v10, s36, v10
v_exp_f32 v10, v10
s_nop 0
v_fmac_f32 v9, v10, v121
v_fmac_f32 v20, v10, v44
v_sub_f32 v10, v122, v8
v_mul_f32 v10, s36, v10
v_exp_f32 v10, v10
s_nop 0
v_fmac_f32 v9, v10, v123
v_fmac_f32 v20, v10, v45
v_sub_f32 v10, v124, v8
v_mul_f32 v10, s36, v10
v_exp_f32 v10, v10
s_nop 0
v_fmac_f32 v9, v10, v125
v_fmac_f32 v20, v10, v46
v_sub_f32 v10, v126, v8
v_mul_f32 v10, s36, v10
v_exp_f32 v10, v10
s_nop 0
v_fmac_f32 v9, v10, v127
v_fmac_f32 v20, v10, v47
v_sub_f32 v10, v128, v8
v_mul_f32 v10, s36, v10
v_exp_f32 v10, v10
s_nop 0
v_fmac_f32 v9, v10, v129
v_fmac_f32 v20, v10, v48
v_sub_f32 v10, v130, v8
v_mul_f32 v10, s36, v10
v_exp_f32 v10, v10
s_nop 0
v_fmac_f32 v9, v10, v131
v_fmac_f32 v20, v10, v49
v_sub_f32 v10, v132, v8
v_mul_f32 v10, s36, v10
v_exp_f32 v10, v10
s_nop 0
v_fmac_f32 v9, v10, v133
v_fmac_f32 v20, v10, v50
v_sub_f32 v10, v134, v8
v_mul_f32 v10, s36, v10
v_exp_f32 v10, v10
s_nop 0
v_fmac_f32 v9, v10, v135
v_fmac_f32 v20, v10, v51
v_sub_f32 v10, v136, v8
v_mul_f32 v10, s36, v10
v_exp_f32 v10, v10
s_nop 0
v_fmac_f32 v9, v10, v137
v_fmac_f32 v20, v10, v52
v_sub_f32 v10, v138, v8
v_mul_f32 v10, s36, v10
v_exp_f32 v10, v10
s_nop 0
v_fmac_f32 v9, v10, v139
v_fmac_f32 v20, v10, v53
v_sub_f32 v10, v140, v8
v_mul_f32 v10, s36, v10
v_exp_f32 v10, v10
s_nop 0
v_fmac_f32 v9, v10, v141
v_fmac_f32 v20, v10, v54
v_sub_f32 v10, v142, v8
v_mul_f32 v10, s36, v10
v_exp_f32 v10, v10
s_nop 0
v_fmac_f32 v9, v10, v143
v_fmac_f32 v20, v10, v55
op_j:
v_rcp_f32 v9, v9
s_nop 0
v_mul_f32 v20, v20, v9
v_cvt_pk_bf16_f32 v20, v20, v20
v_lshlrev_b32 v20, 16, v20
v_lshlrev_b32 v10, 2, v0
ds_write_b32 v10, v20 offset:8192
s_waitcnt lgkmcnt(0)
s_barrier
v_lshrrev_b32 v1, 3, v0
v_lshlrev_b32 v10, 2, v1
ds_read_b32 v24, v10 offset:8192
ds_read_b32 v25, v10 offset:8320
ds_read_b32 v26, v10 offset:8448
ds_read_b32 v27, v10 offset:8576
ds_read_b32 v28, v10 offset:8704
ds_read_b32 v29, v10 offset:8832
ds_read_b32 v30, v10 offset:8960
ds_read_b32 v31, v10 offset:9088
v_mov_b32 v32, 0
v_mov_b32 v33, 0
v_mov_b32 v34, 0
v_mov_b32 v35, 0
v_mov_b32 v36, 0
v_mov_b32 v37, 0
v_mov_b32 v38, 0
v_mov_b32 v39, 0
s_waitcnt vmcnt(0) lgkmcnt(0)
v_lshlrev_b32 v2, 16, v208
v_and_b32 v3, 0xffff0000, v208
v_fmac_f32 v32, v2, v24
v_fmac_f32 v33, v3, v24
v_lshlrev_b32 v2, 16, v209
v_and_b32 v3, 0xffff0000, v209
v_fmac_f32 v34, v2, v24
v_fmac_f32 v35, v3, v24
v_lshlrev_b32 v2, 16, v210
v_and_b32 v3, 0xffff0000, v210
v_fmac_f32 v36, v2, v24
v_fmac_f32 v37, v3, v24
v_lshlrev_b32 v2, 16, v211
v_and_b32 v3, 0xffff0000, v211
v_fmac_f32 v38, v2, v24
v_fmac_f32 v39, v3, v24
v_lshlrev_b32 v2, 16, v212
v_and_b32 v3, 0xffff0000, v212
v_fmac_f32 v32, v2, v25
v_fmac_f32 v33, v3, v25
v_lshlrev_b32 v2, 16, v213
v_and_b32 v3, 0xffff0000, v213
v_fmac_f32 v34, v2, v25
v_fmac_f32 v35, v3, v25
v_lshlrev_b32 v2, 16, v214
v_and_b32 v3, 0xffff0000, v214
v_fmac_f32 v36, v2, v25
v_fmac_f32 v37, v3, v25
v_lshlrev_b32 v2, 16, v215
v_and_b32 v3, 0xffff0000, v215
v_fmac_f32 v38, v2, v25
v_fmac_f32 v39, v3, v25
v_lshlrev_b32 v2, 16, v216
v_and_b32 v3, 0xffff0000, v216
v_fmac_f32 v32, v2, v26
v_fmac_f32 v33, v3, v26
v_lshlrev_b32 v2, 16, v217
v_and_b32 v3, 0xffff0000, v217
v_fmac_f32 v34, v2, v26
v_fmac_f32 v35, v3, v26
v_lshlrev_b32 v2, 16, v218
v_and_b32 v3, 0xffff0000, v218
v_fmac_f32 v36, v2, v26
v_fmac_f32 v37, v3, v26
v_lshlrev_b32 v2, 16, v219
v_and_b32 v3, 0xffff0000, v219
v_fmac_f32 v38, v2, v26
v_fmac_f32 v39, v3, v26
v_lshlrev_b32 v2, 16, v220
v_and_b32 v3, 0xffff0000, v220
v_fmac_f32 v32, v2, v27
v_fmac_f32 v33, v3, v27
v_lshlrev_b32 v2, 16, v221
v_and_b32 v3, 0xffff0000, v221
v_fmac_f32 v34, v2, v27
v_fmac_f32 v35, v3, v27
v_lshlrev_b32 v2, 16, v222
v_and_b32 v3, 0xffff0000, v222
v_fmac_f32 v36, v2, v27
v_fmac_f32 v37, v3, v27
v_lshlrev_b32 v2, 16, v223
v_and_b32 v3, 0xffff0000, v223
v_fmac_f32 v38, v2, v27
v_fmac_f32 v39, v3, v27
v_lshlrev_b32 v2, 16, v224
v_and_b32 v3, 0xffff0000, v224
v_fmac_f32 v32, v2, v28
v_fmac_f32 v33, v3, v28
v_lshlrev_b32 v2, 16, v225
v_and_b32 v3, 0xffff0000, v225
v_fmac_f32 v34, v2, v28
v_fmac_f32 v35, v3, v28
v_lshlrev_b32 v2, 16, v226
v_and_b32 v3, 0xffff0000, v226
v_fmac_f32 v36, v2, v28
v_fmac_f32 v37, v3, v28
v_lshlrev_b32 v2, 16, v227
v_and_b32 v3, 0xffff0000, v227
v_fmac_f32 v38, v2, v28
v_fmac_f32 v39, v3, v28
v_lshlrev_b32 v2, 16, v228
v_and_b32 v3, 0xffff0000, v228
v_fmac_f32 v32, v2, v29
v_fmac_f32 v33, v3, v29
v_lshlrev_b32 v2, 16, v229
v_and_b32 v3, 0xffff0000, v229
v_fmac_f32 v34, v2, v29
v_fmac_f32 v35, v3, v29
v_lshlrev_b32 v2, 16, v230
v_and_b32 v3, 0xffff0000, v230
v_fmac_f32 v36, v2, v29
v_fmac_f32 v37, v3, v29
v_lshlrev_b32 v2, 16, v231
v_and_b32 v3, 0xffff0000, v231
v_fmac_f32 v38, v2, v29
v_fmac_f32 v39, v3, v29
v_lshlrev_b32 v2, 16, v232
v_and_b32 v3, 0xffff0000, v232
v_fmac_f32 v32, v2, v30
v_fmac_f32 v33, v3, v30
v_lshlrev_b32 v2, 16, v233
v_and_b32 v3, 0xffff0000, v233
v_fmac_f32 v34, v2, v30
v_fmac_f32 v35, v3, v30
v_lshlrev_b32 v2, 16, v234
v_and_b32 v3, 0xffff0000, v234
v_fmac_f32 v36, v2, v30
v_fmac_f32 v37, v3, v30
v_lshlrev_b32 v2, 16, v235
v_and_b32 v3, 0xffff0000, v235
v_fmac_f32 v38, v2, v30
v_fmac_f32 v39, v3, v30
v_lshlrev_b32 v2, 16, v236
v_and_b32 v3, 0xffff0000, v236
v_fmac_f32 v32, v2, v31
v_fmac_f32 v33, v3, v31
v_lshlrev_b32 v2, 16, v237
v_and_b32 v3, 0xffff0000, v237
v_fmac_f32 v34, v2, v31
v_fmac_f32 v35, v3, v31
v_lshlrev_b32 v2, 16, v238
v_and_b32 v3, 0xffff0000, v238
v_fmac_f32 v36, v2, v31
v_fmac_f32 v37, v3, v31
v_lshlrev_b32 v2, 16, v239
v_and_b32 v3, 0xffff0000, v239
v_fmac_f32 v38, v2, v31
v_fmac_f32 v39, v3, v31
v_lshlrev_b32 v10, 5, v0
ds_write_b128 v10, v[32:35]
ds_write_b128 v10, v[36:39] offset:16
s_waitcnt lgkmcnt(0)
s_barrier
v_and_b32 v11, 7, v0
v_lshlrev_b32 v12, 2, v11
v_lshrrev_b32 v11, 3, v0
v_lshl_add_u32 v12, v11, 5, v12
v_mov_b32 v20, 0
ds_read_b32 v40, v12 offset:0
ds_read_b32 v41, v12 offset:256
ds_read_b32 v42, v12 offset:512
ds_read_b32 v43, v12 offset:768
ds_read_b32 v44, v12 offset:1024
ds_read_b32 v45, v12 offset:1280
ds_read_b32 v46, v12 offset:1536
ds_read_b32 v47, v12 offset:1792
s_waitcnt lgkmcnt(0)
v_add_f32 v20, v20, v40
v_add_f32 v20, v20, v41
v_add_f32 v20, v20, v42
v_add_f32 v20, v20, v43
v_add_f32 v20, v20, v44
v_add_f32 v20, v20, v45
v_add_f32 v20, v20, v46
v_add_f32 v20, v20, v47
ds_read_b32 v40, v12 offset:2048
ds_read_b32 v41, v12 offset:2304
ds_read_b32 v42, v12 offset:2560
ds_read_b32 v43, v12 offset:2816
ds_read_b32 v44, v12 offset:3072
ds_read_b32 v45, v12 offset:3328
ds_read_b32 v46, v12 offset:3584
ds_read_b32 v47, v12 offset:3840
s_waitcnt lgkmcnt(0)
v_add_f32 v20, v20, v40
v_add_f32 v20, v20, v41
v_add_f32 v20, v20, v42
v_add_f32 v20, v20, v43
v_add_f32 v20, v20, v44
v_add_f32 v20, v20, v45
v_add_f32 v20, v20, v46
v_add_f32 v20, v20, v47
ds_read_b32 v40, v12 offset:4096
ds_read_b32 v41, v12 offset:4352
ds_read_b32 v42, v12 offset:4608
ds_read_b32 v43, v12 offset:4864
ds_read_b32 v44, v12 offset:5120
ds_read_b32 v45, v12 offset:5376
ds_read_b32 v46, v12 offset:5632
ds_read_b32 v47, v12 offset:5888
s_waitcnt lgkmcnt(0)
v_add_f32 v20, v20, v40
v_add_f32 v20, v20, v41
v_add_f32 v20, v20, v42
v_add_f32 v20, v20, v43
v_add_f32 v20, v20, v44
v_add_f32 v20, v20, v45
v_add_f32 v20, v20, v46
v_add_f32 v20, v20, v47
ds_read_b32 v40, v12 offset:6144
ds_read_b32 v41, v12 offset:6400
ds_read_b32 v42, v12 offset:6656
ds_read_b32 v43, v12 offset:6912
ds_read_b32 v44, v12 offset:7168
ds_read_b32 v45, v12 offset:7424
ds_read_b32 v46, v12 offset:7680
ds_read_b32 v47, v12 offset:7936
s_waitcnt lgkmcnt(0)
v_add_f32 v20, v20, v40
v_add_f32 v20, v20, v41
v_add_f32 v20, v20, v42
v_add_f32 v20, v20, v43
v_add_f32 v20, v20, v44
v_add_f32 v20, v20, v45
v_add_f32 v20, v20, v46
v_add_f32 v20, v20, v47
s_mul_i32 s24, s3, 16
s_add_u32 s24, s24, s25
s_mul_i32 s24, s24, 2560
s_lshl_b32 s27, s26, 8
s_add_u32 s24, s24, s27
s_add_u32 s24, s24, 2162688
v_lshlrev_b32 v1, 2, v0
v_cmp_gt_u32 vcc, 64, v0
s_mov_b32 s42, s26
s_and_saveexec_b64 s[44:45], vcc
s_cbranch_execz op_kernel_end
buffer_store_dword v20, v1, s[20:23], s24 offen sc0 sc1
s_waitcnt vmcnt(0)
s_mul_i32 s40, s3, 10
s_mov_b32 s12, s10
s_and_b32 s13, s11, 0xffff
s_mov_b32 s14, 256
s_mov_b32 s15, 0x20000
s_mov_b32 s48, s8
s_and_b32 s49, s9, 0xffff
s_mov_b32 s50, 2560
s_mov_b32 s51, 0x20000
s_add_u32 s40, s40, s42
s_lshl_b32 s40, s40, 2
v_mov_b32 v5, 1
v_mov_b32 v6, s40
v_cmp_eq_u32 vcc, 0, v0
s_and_saveexec_b64 s[44:45], vcc
buffer_atomic_add v5, v6, s[12:15], 0 offen sc0 sc1
s_waitcnt vmcnt(0)
s_mov_b64 exec, s[44:45]
s_nop 4
v_readfirstlane_b32 s41, v5
s_nop 4
s_cmp_lg_u32 s41, 15
s_cbranch_scc1 op_kernel_end
s_mul_i32 s24, s3, 40960
s_lshl_b32 s27, s42, 8
s_add_u32 s24, s24, s27
s_add_u32 s24, s24, 2162688
buffer_load_dword v40, v1, s[20:23], s24 offen sc0 sc1
s_add_u32 s24, s24, 2560
buffer_load_dword v41, v1, s[20:23], s24 offen sc0 sc1
s_add_u32 s24, s24, 2560
buffer_load_dword v42, v1, s[20:23], s24 offen sc0 sc1
s_add_u32 s24, s24, 2560
buffer_load_dword v43, v1, s[20:23], s24 offen sc0 sc1
s_add_u32 s24, s24, 2560
buffer_load_dword v44, v1, s[20:23], s24 offen sc0 sc1
s_add_u32 s24, s24, 2560
buffer_load_dword v45, v1, s[20:23], s24 offen sc0 sc1
s_add_u32 s24, s24, 2560
buffer_load_dword v46, v1, s[20:23], s24 offen sc0 sc1
s_add_u32 s24, s24, 2560
buffer_load_dword v47, v1, s[20:23], s24 offen sc0 sc1
s_add_u32 s24, s24, 2560
buffer_load_dword v48, v1, s[20:23], s24 offen sc0 sc1
s_add_u32 s24, s24, 2560
buffer_load_dword v49, v1, s[20:23], s24 offen sc0 sc1
s_add_u32 s24, s24, 2560
buffer_load_dword v50, v1, s[20:23], s24 offen sc0 sc1
s_add_u32 s24, s24, 2560
buffer_load_dword v51, v1, s[20:23], s24 offen sc0 sc1
s_add_u32 s24, s24, 2560
buffer_load_dword v52, v1, s[20:23], s24 offen sc0 sc1
s_add_u32 s24, s24, 2560
buffer_load_dword v53, v1, s[20:23], s24 offen sc0 sc1
s_add_u32 s24, s24, 2560
buffer_load_dword v54, v1, s[20:23], s24 offen sc0 sc1
s_add_u32 s24, s24, 2560
buffer_load_dword v55, v1, s[20:23], s24 offen sc0 sc1
s_add_u32 s24, s24, 2560
s_waitcnt vmcnt(0)
v_add_f32 v40, v40, v41
v_add_f32 v40, v40, v42
v_add_f32 v40, v40, v43
v_add_f32 v40, v40, v44
v_add_f32 v40, v40, v45
v_add_f32 v40, v40, v46
v_add_f32 v40, v40, v47
v_add_f32 v40, v40, v48
v_add_f32 v40, v40, v49
v_add_f32 v40, v40, v50
v_add_f32 v40, v40, v51
v_add_f32 v40, v40, v52
v_add_f32 v40, v40, v53
v_add_f32 v40, v40, v54
v_add_f32 v40, v40, v55
v_cvt_pk_bf16_f32 v8, v40, v40
s_mul_i32 s24, s3, 1280
s_lshl_b32 s27, s42, 7
s_add_u32 s24, s24, s27
v_lshlrev_b32 v1, 1, v0
buffer_store_short v8, v1, s[48:51], s24 offen
s_waitcnt vmcnt(0)

op_kernel_end:
s_endpgm
.section .rodata,"a"
.p2align 6
.amdhsa_kernel qp_kernel
  .amdhsa_next_free_vgpr 64
  .amdhsa_next_free_sgpr 56
  .amdhsa_accum_offset 64
  .amdhsa_group_segment_fixed_size 0
  .amdhsa_kernarg_size 104
  .amdhsa_user_sgpr_count 2
  .amdhsa_user_sgpr_kernarg_segment_ptr 1
  .amdhsa_system_sgpr_workgroup_id_x 1
.end_amdhsa_kernel
.p2align 6
.amdhsa_kernel at_kernel
  .amdhsa_next_free_vgpr 128
  .amdhsa_next_free_sgpr 56
  .amdhsa_accum_offset 128
  .amdhsa_group_segment_fixed_size 0
  .amdhsa_kernarg_size 104
  .amdhsa_user_sgpr_count 2
  .amdhsa_user_sgpr_kernarg_segment_ptr 1
  .amdhsa_system_sgpr_workgroup_id_x 1
.end_amdhsa_kernel
.p2align 6
.amdhsa_kernel op_kernel
  .amdhsa_next_free_vgpr 240
  .amdhsa_next_free_sgpr 56
  .amdhsa_accum_offset 240
  .amdhsa_group_segment_fixed_size 0
  .amdhsa_kernarg_size 104
  .amdhsa_user_sgpr_count 2
  .amdhsa_user_sgpr_kernarg_segment_ptr 1
  .amdhsa_system_sgpr_workgroup_id_x 1
.end_amdhsa_kernel
```
